```python
import torch

def _softmax(x, axis=-1):
    return torch.softmax(x, dim=axis)
def _gelu(x):
    return torch.nn.functional.gelu(x, approximate="tanh")
def _silu(x):
    return torch.nn.functional.silu(x)
def _sigmoid(x):
    return torch.sigmoid(x)
def _layernorm(x, axis=-1, eps=1e-5):
    m = x.mean(dim=axis, keepdim=True)
    v = x.var(dim=axis, keepdim=True, unbiased=False)
    return (x - m) / torch.sqrt(v + eps)
def _scatter_add(tgt, idx, src, axis=0):
    return tgt.clone().index_add_(axis, idx, src)
def _segment_sum(src, seg, n):
    out = torch.zeros((n,) + src.shape[1:], dtype=src.dtype)
    return out.index_add_(0, seg, src)
def _pad(x, pw):
    flat = tuple(v for pair in reversed(pw) for v in pair)
    return torch.nn.functional.pad(x, flat)

kernel_name = 'gated_mix__linear_kernel_hedgehog__sliding_local_dilated__prompt'

def setup_inputs():

    _w = (lambda a: (lambda t: t.to(torch.bfloat16) if t.is_floating_point() else t)(torch.as_tensor(a)))
    def _A_setup():
        B, S, D, H = 1, 2048, 512, 32
        Dh = D // H
        return {
            "x": _w((lambda *s: torch.randn(*s, dtype=torch.bfloat16) * 0.05)(B, S, D)),
            "wqkv": _w((lambda *s: torch.randn(*s, dtype=torch.bfloat16) * 1.6)(D, 3 * D)),
            "w_phi": _w((lambda *s: torch.randn(*s, dtype=torch.bfloat16) * 1.6)(H, Dh, Dh) * (Dh ** -0.5)),
            "wo": _w((lambda *s: torch.randn(*s, dtype=torch.bfloat16) * 0.1)(D, D)),
        }
    _A_in = _A_setup()

    def _B_setup():
        B, S, D = 1, 2048, 512
        return {
            "x": _w((lambda *s: torch.randn(*s, dtype=torch.bfloat16) * 0.05)(B, S, D)),
            "wqkv": _w((lambda *s: torch.randn(*s, dtype=torch.bfloat16) * 0.8)(D, 3 * D)),
            "wo": _w((lambda *s: torch.randn(*s, dtype=torch.bfloat16) * 0.05)(D, D)),
        }
    _B_in = _B_setup()

    return {
        "A_x": _A_in["x"],
        "A_wqkv": _A_in["wqkv"],
        "A_w_phi": _A_in["w_phi"],
        "A_wo": _A_in["wo"],
        "B_x": _B_in["x"],
        "B_wqkv": _B_in["wqkv"],
        "B_wo": _B_in["wo"],
        "gate_w": _w((lambda *s: torch.randn(*s, dtype=torch.bfloat16) * 0.05)(512) * 16.0),
    }

def reference(A_x, A_wqkv, A_w_phi, A_wo, B_x, B_wqkv, B_wo, gate_w):
    def _A_ref(x, wqkv, w_phi, wo):
        B, S, D = x.shape
        H = 32; Dh = D // H
        qkv = (lambda x, *d: x.permute(*d))((x @ wqkv).reshape(B, S, 3, H, Dh), 2, 0, 3, 1, 4)
        q, k, v = qkv[0], qkv[1], qkv[2]
        pq = torch.einsum("bhsd,hdf->bhsf", q, w_phi)
        pk = torch.einsum("bhsd,hdf->bhsf", k, w_phi)
        phi_q = torch.concatenate([_softmax(pq, axis=-1), _softmax(-pq, axis=-1)], axis=-1)
        phi_k = torch.concatenate([_softmax(pk, axis=-1), _softmax(-pk, axis=-1)], axis=-1)
        kv = torch.einsum("bhsf,bhsd->bhfd", phi_k, v)
        z  = torch.einsum("bhsf->bhf", phi_k)
        num = torch.einsum("bhqf,bhfd->bhqd", phi_q, kv)
        den = torch.einsum("bhqf,bhf->bhq", phi_q, z)[..., None] + 1e-6
        o = num / den
        return (lambda x, *d: x.permute(*d))(o, 0, 2, 1, 3).reshape(B, S, D) @ wo

    def _B_ref(x, wqkv, wo):
        B, S, D = x.shape
        H = 32; Dh = D // H
        W, dil = 8, 2
        qkv = (lambda x, *d: x.permute(*d))((x @ wqkv).reshape(B, S, 3, H, Dh), 2, 0, 3, 1, 4)
        q, k, v = qkv[0], qkv[1], qkv[2]
        scale = Dh ** -0.5
        pos = torch.arange(S)
        off = torch.arange(W) * dil
        idx = pos[:, None] - off[None, :]
        mask = idx >= 0
        idx_c = torch.where(mask, idx, 0).reshape(-1)
        kg = k[:, :, idx_c, :].reshape(B, H, S, W, Dh)
        vg = v[:, :, idx_c, :].reshape(B, H, S, W, Dh)
        logits = torch.einsum("bhsd,bhswd->bhsw", q, kg) * scale
        logits = torch.where(mask[None, None, :, :], logits, -1e9)
        attn = _softmax(logits, axis=-1)
        o = torch.einsum("bhsw,bhswd->bhsd", attn, vg)
        return (lambda x, *d: x.permute(*d))(o, 0, 2, 1, 3).reshape(B, S, D) @ wo

    x = A_x
    g = _sigmoid((x * gate_w).sum(-1, keepdims=True))
    a = _A_ref(x, A_wqkv, A_w_phi, A_wo)
    b = _B_ref(x, B_wqkv, B_wo)
    return g * a + (1 - g) * b
```

```asm
; @launch grid=(256,1,1) block=(512,1,1) lds=163840
.amdgcn_target "amdgcn-amd-amdhsa--gfx950"
.text
.globl gated_mix__linear_kernel_hedgehog__sliding_local_dilated__prompt_kernel
.p2align 8
.type gated_mix__linear_kernel_hedgehog__sliding_local_dilated__prompt_kernel,@function
gated_mix__linear_kernel_hedgehog__sliding_local_dilated__prompt_kernel:
L_start:
    s_load_dwordx8 s[24:31], s[0:1], 0
    s_load_dwordx8 s[32:39], s[0:1], 40
    s_load_dwordx4 s[4:7], s[0:1], 72
    s_cmp_ge_u32 s2, 256
    s_cbranch_scc1 L_end
    s_getpc_b64 s[52:53]
L_pc:
    s_lshr_b32 s50, s2, 3
    s_lshl_b32 s50, s50, 11
    v_lshl_add_u32 v2, v0, 4, s50
    v_cmp_gt_u32 vcc, 128, v0
    v_mov_b32 v3, L_last-L_pc-16
    v_cmp_gt_u32 s[50:51], v3, v2
    s_nop 0
    s_and_b64 vcc, vcc, s[50:51]
    s_and_saveexec_b64 s[50:51], vcc
    s_cbranch_execz L_nopf
    global_load_dwordx4 v[252:255], v2, s[52:53]
L_nopf:
    s_mov_b64 exec, -1
    v_lshrrev_b32 v1, 6, v0
    v_and_b32 v0, 63, v0
    s_and_b32 s50, s2, 7
    s_lshr_b32 s51, s2, 3
    v_readfirstlane_b32 s40, v1
    s_and_b32 s41, s50, 1
    s_lshl_b32 s41, s41, 3
    s_and_b32 s54, s51, 7
    s_add_u32 s41, s41, s54
    s_lshr_b32 s54, s51, 3
    s_and_b32 s43, s54, 1
    s_and_b32 s42, s50, 6
    s_lshr_b32 s55, s54, 1
    s_add_u32 s42, s42, s55
    s_lshl_b32 s44, s54, 1
    s_add_u32 s44, s44, s41
    s_and_b32 s44, s44, 7
    s_lshl_b32 s45, s50, 2
    s_add_u32 s45, s45, s54
    s_and_b32 s46, s51, 7
    s_lshl_b32 s48, s40, 10
    v_lshrrev_b32 v5, 3, v0
    v_lshrrev_b32 v6, 4, v0
    v_and_b32 v7, 7, v0
    s_and_b32 s54, s40, 1
    s_lshl_b32 s55, s54, 2
    v_add_u32 v8, s55, v6
    v_xor_b32 v8, v8, v7
    v_lshlrev_b32 v8, 4, v8
    s_lshr_b32 s55, s40, 1
    s_lshl_b32 s55, s55, 4
    s_add_u32 s55, s55, s54
    s_lshl_b32 s55, s55, 10
    v_lshl_add_u32 v1, v5, 11, v8
    v_add_u32 v1, s55, v1
    v_add_u32 v2, 0x10000, v1
    v_and_b32 v6, 1, v6
    v_lshlrev_b32 v6, 2, v6
    v_xor_b32 v6, v6, v7
    v_lshlrev_b32 v6, 4, v6
    s_lshl_b32 s55, s40, 3
    v_add_u32 v5, s55, v5
    s_movk_i32 s55, 3072
    v_mad_u32_u24 v3, v5, s55, v6
    v_lshl_add_u32 v4, v5, 10, v6
    v_and_b32 v6, 32, v0
    v_xor_b32 v4, v4, v6
    v_lshlrev_b32 v13, 4, v0
    s_lshl_b32 s54, s41, 17
    s_lshl_b32 s55, s42, 7
    s_add_u32 s50, s44, 0
    s_and_b32 s50, s50, 7
    s_lshl_b32 s64, s50, 7
    s_add_u32 s64, s64, s54
    s_mul_i32 s72, s50, 0x30000
    s_add_u32 s72, s72, s55
    s_add_u32 s50, s44, 1
    s_and_b32 s50, s50, 7
    s_lshl_b32 s65, s50, 7
    s_add_u32 s65, s65, s54
    s_mul_i32 s73, s50, 0x30000
    s_add_u32 s73, s73, s55
    s_and_b32 s84, s40, 3
    s_lshr_b32 s85, s40, 2
    s_mov_b32 s10, 0x200000
    s_mov_b32 s11, 0x20000
    s_mov_b32 s14, 0x180000
    s_mov_b32 s15, 0x20000
    s_cmp_eq_u32 s43, 0
    s_waitcnt lgkmcnt(0)
    s_mov_b32 s8, s24
    s_mov_b32 s9, s25
    s_cbranch_scc0 L_typeB
    s_mov_b32 s12, s26
    s_mov_b32 s13, s27
    s_add_u32 m0, s48, 0x0
    s_nop 0
    buffer_load_dwordx4 v1, s[8:11], s64 offen lds
    s_add_u32 m0, s48, 0x2000
    s_nop 0
    buffer_load_dwordx4 v2, s[8:11], s64 offen lds
    s_add_u32 m0, s48, 0x4000
    s_add_u32 s49, s72, 0x400
    buffer_load_dwordx4 v3, s[12:15], s49 offen lds
    s_add_u32 m0, s48, 0x6000
    s_nop 0
    buffer_load_dwordx4 v1, s[8:11], s65 offen lds
    s_add_u32 m0, s48, 0x8000
    s_nop 0
    buffer_load_dwordx4 v2, s[8:11], s65 offen lds
    s_mov_b64 s[20:21], s[30:31]
    s_mov_b64 s[24:25], s[34:35]
    s_mov_b64 s[32:33], s[28:29]
    s_mov_b64 s[28:29], s[38:39]
    s_mov_b64 s[36:37], s[4:5]
    s_mov_b64 s[16:17], s[6:7]
    s_add_u32 s50, s44, 2
    s_and_b32 s50, s50, 7
    s_lshl_b32 s66, s50, 7
    s_add_u32 s66, s66, s54
    s_mul_i32 s74, s50, 0x30000
    s_add_u32 s74, s74, s55
    s_add_u32 s50, s44, 3
    s_and_b32 s50, s50, 7
    s_lshl_b32 s67, s50, 7
    s_add_u32 s67, s67, s54
    s_mul_i32 s75, s50, 0x30000
    s_add_u32 s75, s75, s55
    s_add_u32 s50, s44, 4
    s_and_b32 s50, s50, 7
    s_lshl_b32 s68, s50, 7
    s_add_u32 s68, s68, s54
    s_mul_i32 s76, s50, 0x30000
    s_add_u32 s76, s76, s55
    s_add_u32 s50, s44, 5
    s_and_b32 s50, s50, 7
    s_lshl_b32 s69, s50, 7
    s_add_u32 s69, s69, s54
    s_mul_i32 s77, s50, 0x30000
    s_add_u32 s77, s77, s55
    s_add_u32 s50, s44, 6
    s_and_b32 s50, s50, 7
    s_lshl_b32 s70, s50, 7
    s_add_u32 s70, s70, s54
    s_mul_i32 s78, s50, 0x30000
    s_add_u32 s78, s78, s55
    s_add_u32 s50, s44, 7
    s_and_b32 s50, s50, 7
    s_lshl_b32 s71, s50, 7
    s_add_u32 s71, s71, s54
    s_mul_i32 s79, s50, 0x30000
    s_add_u32 s79, s79, s55
    s_mov_b32 s34, 0x4000
    s_mov_b32 s35, 0x20000
    s_mov_b32 s18, 0x10000000
    s_mov_b32 s19, 0x20000
    s_mov_b32 s22, 0x80000
    s_mov_b32 s23, 0x20000
    s_mov_b32 s26, 0x80000
    s_mov_b32 s27, 0x20000
    s_mov_b32 s30, 0x200000
    s_mov_b32 s31, 0x20000
    s_mov_b32 s38, 0x100
    s_mov_b32 s39, 0x20000
    s_cmp_lt_u32 s40, 2
    s_cbranch_scc0 L_nomisc_1
    s_lshl_b32 s50, s42, 11
    s_add_u32 s50, s50, s48
    v_add_u32 v20, s50, v13
    s_add_u32 m0, s48, 0x26000
    s_nop 0
    buffer_load_dwordx4 v20, s[32:35], 0 offen lds
L_nomisc_1:
    v_mov_b32 v126, 0x26a00
    v_mov_b32 v127, 1
    v_mov_b32 v16, 0
    v_mov_b32 v17, 0
    v_mov_b32 v18, 0
    v_mov_b32 v19, 0
    ds_write_b128 v126, v[16:19]
    ds_write_b128 v126, v[16:19] offset:16
    s_mov_b32 s55, 0
    s_mov_b32 s52, 0x3fb8aa3b
    s_mov_b32 s53, 0x3fb8aa3b
    s_add_u32 s50, s45, 0
    s_and_b32 s50, s50, 3
    s_lshl_b32 s50, s50, 16
    s_lshl_b32 s51, s46, 7
    s_add_u32 s80, s50, s51
    s_add_u32 s50, s45, 1
    s_and_b32 s50, s50, 3
    s_lshl_b32 s50, s50, 16
    s_lshl_b32 s51, s46, 7
    s_add_u32 s81, s50, s51
    s_add_u32 s50, s45, 2
    s_and_b32 s50, s50, 3
    s_lshl_b32 s50, s50, 16
    s_lshl_b32 s51, s46, 7
    s_add_u32 s82, s50, s51
    s_add_u32 s50, s45, 3
    s_and_b32 s50, s50, 3
    s_lshl_b32 s50, s50, 16
    s_lshl_b32 s51, s46, 7
    s_add_u32 s83, s50, s51
    v_and_b32 v16, 31, v0
    v_lshrrev_b32 v17, 5, v0
    v_bfe_u32 v18, v0, 1, 3
    v_xor_b32 v17, v17, v18
    v_lshlrev_b32 v17, 4, v17
    s_lshl_b32 s50, s84, 12
    v_lshl_add_u32 v5, v16, 7, v17
    v_add_u32 v5, s50, v5
    v_xor_b32 v6, 32, v5
    v_xor_b32_e64 v7, 64, v5
    v_xor_b32 v8, 0x60, v5
    v_bfe_u32 v16, v0, 2, 2
    v_lshrrev_b32 v17, 5, v0
    v_lshl_add_u32 v16, v17, 3, v16
    v_lshlrev_b32 v16, 7, v16
    v_bfe_u32 v17, v0, 3, 1
    v_xor_b32_e64 v17, s55, v17
    v_lshl_add_u32 v16, v17, 6, v16
    v_bfe_u32 v17, v0, 4, 1
    v_lshl_add_u32 v16, v17, 5, v16
    v_and_b32 v17, 3, v0
    v_lshl_add_u32 v9, v17, 3, v16
    v_xor_b32 v10, 64, v9
    v_and_b32 v16, 1, v0
    v_lshlrev_b32 v16, 9, v16
    v_bfe_u32 v17, v0, 2, 2
    v_lshrrev_b32_e64 v18, 5, v0
    v_lshl_add_u32 v17, v18, 2, v17
    v_lshl_add_u32 v16, v17, 5, v16
    v_bfe_u32 v17, v0, 4, 1
    v_lshl_add_u32 v16, v17, 4, v16
    v_bfe_u32 v17, v0, 1, 1
    v_lshl_add_u32 v16, v17, 3, v16
    v_add_u32 v12, 0x26000, v16
    v_lshrrev_b32 v16, 5, v0
    v_xor_b32 v124, 0x8000, v4
    v_and_b32 v20, 31, v0
    v_lshrrev_b32 v17, 5, v0
    v_bfe_u32 v18, v0, 1, 2
    v_xor_b32 v17, v17, v18
    v_lshlrev_b32 v17, 4, v17
    s_lshl_b32 s50, s84, 11
    v_lshl_add_u32 v20, v20, 6, v17
    v_add_u32 v20, s50, v20
    s_lshl_b32 s50, s84, 11
    s_add_u32 s50, s50, 0x1c000
    v_add_u32 v11, s50, v13
    s_cmp_eq_u32 s85, 0
    s_cbranch_scc0 L_AK
    s_branch L_AM
L_TretP:
    s_cmp_eq_u32 s62, 0
    s_cbranch_scc1 L_TretA
    s_branch L_TretB
    .p2align 12
L_AM:
    v_add_u32 v116, 0x1c000, v20
    v_xor_b32 v117, 32, v116
    v_and_b32 v18, 15, v0
    v_lshl_add_u32 v18, v16, 4, v18
    v_lshlrev_b32 v18, 4, v18
    v_lshlrev_b32 v17, 4, v16
    v_add_u32 v17, 0x200, v17
    v_and_b32 v19, 16, v0
    v_cmp_eq_u32 vcc, 0, v19
    s_nop 1
    v_cndmask_b32 v122, v17, v18, vcc
    v_add_u32 v122, 0x26c00, v122
    s_lshl_b32 s50, s41, 2
    s_add_u32 s50, s50, s84
    s_lshl_b32 s56, s50, 5
    s_lshl_b32 s51, s42, 1
    s_add_u32 s56, s56, s51
    s_lshl_b32 s57, s56, 7
    s_add_u32 s57, s57, 0x560000
    s_lshl_b32 s56, s56, 11
    v_xor_b32 v56, 0x8000, v1
    v_xor_b32 v57, 0x8000, v2
    v_add_u32 v58, 0x18000, v3
    v_mov_b32 v48, -1
    v_mov_b32 v49, -1
    v_mov_b32 v50, -1
    v_mov_b32 v51, -1
    v_and_b32 v17, 15, v0
    v_lshrrev_b32 v18, 4, v0
    v_lshlrev_b32 v17, 4, v17
    v_lshl_add_u32 v119, v18, 9, v17
    v_bfe_u32 v17, v0, 2, 3
    v_lshrrev_b32 v18, 5, v0
    v_lshl_add_u32 v17, v18, 4, v17
    v_lshlrev_b32 v17, 7, v17
    v_bfe_u32 v18, v0, 3, 1
    v_lshl_add_u32 v17, v18, 6, v17
    v_bfe_u32 v18, v0, 4, 1
    v_lshl_add_u32 v17, v18, 5, v17
    v_and_b32 v18, 3, v0
    v_lshl_add_u32 v112, v18, 3, v17
    s_lshr_b32 s50, s40, 1
    s_lshl_b32 s50, s50, 15
    v_add_u32 v112, s50, v112
    v_xor_b32 v113, 64, v112
    v_xor_b32 v115, 32, v112
    v_xor_b32 v118, 32, v113
    s_bfe_u32 s51, s40, 0x10001
    s_lshl_b32 s50, s51, 3
    v_and_b32 v114, 6, v0
    v_add_u32 v114, s50, v114
    v_lshlrev_b32_e64 v114, 7, v114
    s_mov_b32 s62, 0
    s_mov_b64 exec, 0
    s_cmp_eq_u32 s40, 0
    s_cbranch_scc1 L_TA0_0
    s_cmp_eq_u32 s40, 1
    s_cbranch_scc1 L_TA1_0
    s_cmp_eq_u32 s40, 2
    s_cbranch_scc1 L_TA2_0
    s_branch L_TP0_0
L_TretA:
    s_mov_b64 exec, -1
    s_add_u32 m0, s48, 0xa000
    s_add_u32 s49, s73, 0x400
    buffer_load_dwordx4 v3, s[12:15], s49 offen lds
    s_add_u32 m0, s48, 0xc000
    s_nop 0
    buffer_load_dwordx4 v1, s[8:11], s66 offen lds
    s_add_u32 m0, s48, 0xe000
    s_nop 0
    buffer_load_dwordx4 v2, s[8:11], s66 offen lds
    s_add_u32 m0, s48, 0x10000
    s_add_u32 s49, s74, 0x400
    buffer_load_dwordx4 v3, s[12:15], s49 offen lds
    s_waitcnt vmcnt(6) lgkmcnt(0)
    s_barrier
    s_add_u32 m0, s48, 0x12000
    s_nop 0
    buffer_load_dwordx4 v1, s[8:11], s67 offen lds
    s_add_u32 m0, s48, 0x13000
    s_nop 0
    buffer_load_dwordx4 v56, s[8:11], s67 offen lds
    ds_read_b128 v[128:131], v5 offset:0
    ds_read_b128 v[132:135], v6 offset:0
    ds_read_b128 v[136:139], v7 offset:0
    ds_read_b128 v[140:143], v8 offset:0
    s_add_u32 m0, s48, 0x14000
    s_nop 0
    buffer_load_dwordx4 v2, s[8:11], s67 offen lds
    s_add_u32 m0, s48, 0x15000
    s_nop 0
    buffer_load_dwordx4 v57, s[8:11], s67 offen lds
    s_add_u32 m0, s48, 0x16000
    s_add_u32 s49, s75, 0x400
    buffer_load_dwordx4 v3, s[12:15], s49 offen lds
    s_waitcnt vmcnt(8) lgkmcnt(0)
    s_barrier
    s_add_u32 m0, s48, 0x0
    s_nop 0
    buffer_load_dwordx4 v1, s[8:11], s68 offen lds
    s_add_u32 m0, s48, 0x1000
    s_nop 0
    buffer_load_dwordx4 v56, s[8:11], s68 offen lds
    ds_read_b128 v[144:147], v5 offset:24576
    ds_read_b128 v[148:151], v6 offset:24576
    ds_read_b128 v[152:155], v7 offset:24576
    ds_read_b128 v[156:159], v8 offset:24576
    s_add_u32 m0, s48, 0x2000
    s_nop 0
    buffer_load_dwordx4 v2, s[8:11], s68 offen lds
    s_add_u32 m0, s48, 0x3000
    s_nop 0
    buffer_load_dwordx4 v57, s[8:11], s68 offen lds
    s_add_u32 m0, s48, 0x4000
    s_add_u32 s49, s76, 0x400
    buffer_load_dwordx4 v3, s[12:15], s49 offen lds
    s_waitcnt vmcnt(10) lgkmcnt(0)
    s_barrier
    s_add_u32 m0, s48, 0x6000
    s_nop 0
    buffer_load_dwordx4 v1, s[8:11], s69 offen lds
    s_add_u32 m0, s48, 0x7000
    s_nop 0
    buffer_load_dwordx4 v56, s[8:11], s69 offen lds
    ds_read_b128 v[160:163], v5 offset:49152
    ds_read_b128 v[164:167], v6 offset:49152
    ds_read_b128 v[168:171], v7 offset:49152
    ds_read_b128 v[172:175], v8 offset:49152
    s_add_u32 m0, s48, 0x8000
    s_nop 0
    buffer_load_dwordx4 v2, s[8:11], s69 offen lds
    s_add_u32 m0, s48, 0x9000
    s_nop 0
    buffer_load_dwordx4 v57, s[8:11], s69 offen lds
    s_add_u32 m0, s48, 0xa000
    s_add_u32 s49, s77, 0x400
    buffer_load_dwordx4 v3, s[12:15], s49 offen lds
    s_waitcnt vmcnt(10) lgkmcnt(0)
    s_barrier
    s_add_u32 m0, s48, 0xc000
    s_nop 0
    buffer_load_dwordx4 v1, s[8:11], s70 offen lds
    s_add_u32 m0, s48, 0xd000
    s_nop 0
    buffer_load_dwordx4 v56, s[8:11], s70 offen lds
    v_add_u32 v5, 0xc000, v5
    v_add_u32 v6, 0xc000, v6
    v_add_u32 v7, 0xc000, v7
    v_add_u32 v8, 0xc000, v8
    ds_read_b128 v[176:179], v5 offset:24576
    ds_read_b128 v[180:183], v6 offset:24576
    ds_read_b128 v[184:187], v7 offset:24576
    ds_read_b128 v[188:191], v8 offset:24576
    s_add_u32 m0, s48, 0xe000
    s_nop 0
    buffer_load_dwordx4 v2, s[8:11], s70 offen lds
    s_add_u32 m0, s48, 0xf000
    s_nop 0
    buffer_load_dwordx4 v57, s[8:11], s70 offen lds
    s_add_u32 m0, s48, 0x10000
    s_add_u32 s49, s78, 0x400
    buffer_load_dwordx4 v3, s[12:15], s49 offen lds
    s_waitcnt vmcnt(10) lgkmcnt(0)
    s_barrier
    s_add_u32 m0, s48, 0x12000
    s_nop 0
    buffer_load_dwordx4 v1, s[8:11], s71 offen lds
    s_add_u32 m0, s48, 0x13000
    s_nop 0
    buffer_load_dwordx4 v56, s[8:11], s71 offen lds
    v_add_u32 v5, 0xffff4000, v5
    v_add_u32 v6, 0xffff4000, v6
    v_add_u32 v7, 0xffff4000, v7
    v_add_u32 v8, 0xffff4000, v8
    ds_read_b128 v[192:195], v5 offset:0
    ds_read_b128 v[196:199], v6 offset:0
    ds_read_b128 v[200:203], v7 offset:0
    ds_read_b128 v[204:207], v8 offset:0
    s_add_u32 m0, s48, 0x14000
    s_nop 0
    buffer_load_dwordx4 v2, s[8:11], s71 offen lds
    s_add_u32 m0, s48, 0x15000
    s_nop 0
    buffer_load_dwordx4 v57, s[8:11], s71 offen lds
    s_add_u32 m0, s48, 0x16000
    s_add_u32 s49, s79, 0x400
    buffer_load_dwordx4 v3, s[12:15], s49 offen lds
    s_waitcnt vmcnt(10) lgkmcnt(0)
    s_barrier
    s_add_u32 m0, s48, 0x1a000
    s_add_u32 s49, s73, 0x800
    buffer_load_dwordx4 v3, s[12:15], s49 offen lds
    s_add_u32 m0, s48, 0x1b000
    s_add_u32 s49, s73, 0x800
    buffer_load_dwordx4 v58, s[12:15], s49 offen lds
    ds_read_b128 v[208:211], v5 offset:24576
    ds_read_b128 v[212:215], v6 offset:24576
    ds_read_b128 v[216:219], v7 offset:24576
    ds_read_b128 v[220:223], v8 offset:24576
    s_add_u32 m0, s48, 0x22000
    s_add_u32 s49, s74, 0x800
    buffer_load_dwordx4 v3, s[12:15], s49 offen lds
    s_add_u32 m0, s48, 0x23000
    s_add_u32 s49, s74, 0x800
    buffer_load_dwordx4 v58, s[12:15], s49 offen lds
    s_add_u32 m0, s48, 0x24000
    s_add_u32 s49, s75, 0x800
    buffer_load_dwordx4 v3, s[12:15], s49 offen lds
    s_waitcnt vmcnt(10) lgkmcnt(0)
    s_barrier
    s_add_u32 m0, s48, 0x0
    s_add_u32 s49, s76, 0x800
    buffer_load_dwordx4 v3, s[12:15], s49 offen lds
    s_add_u32 m0, s48, 0x1000
    s_add_u32 s49, s76, 0x800
    buffer_load_dwordx4 v58, s[12:15], s49 offen lds
    ds_read_b128 v[224:227], v5 offset:49152
    ds_read_b128 v[228:231], v6 offset:49152
    ds_read_b128 v[232:235], v7 offset:49152
    ds_read_b128 v[236:239], v8 offset:49152
    s_add_u32 m0, s48, 0x2000
    s_add_u32 s49, s77, 0x800
    buffer_load_dwordx4 v3, s[12:15], s49 offen lds
    s_add_u32 m0, s48, 0x3000
    s_add_u32 s49, s77, 0x800
    buffer_load_dwordx4 v58, s[12:15], s49 offen lds
    s_add_u32 m0, s48, 0x4000
    s_add_u32 s49, s78, 0x800
    buffer_load_dwordx4 v3, s[12:15], s49 offen lds
    s_waitcnt vmcnt(10) lgkmcnt(0)
    s_barrier
    s_add_u32 m0, s48, 0x6000
    s_add_u32 s49, s79, 0x800
    buffer_load_dwordx4 v3, s[12:15], s49 offen lds
    s_add_u32 m0, s48, 0x7000
    s_add_u32 s49, s79, 0x800
    buffer_load_dwordx4 v58, s[12:15], s49 offen lds
    v_add_u32 v5, 0xc000, v5
    v_add_u32 v6, 0xc000, v6
    v_add_u32 v7, 0xc000, v7
    v_add_u32 v8, 0xc000, v8
    ds_read_b128 v[240:243], v5 offset:24576
    ds_read_b128 v[244:247], v6 offset:24576
    ds_read_b128 v[248:251], v7 offset:24576
    ds_read_b128 v[252:255], v8 offset:24576
    s_add_u32 m0, s48, 0x20000
    s_nop 0
    buffer_load_dwordx4 v3, s[12:15], s72 offen lds
    s_add_u32 m0, s48, 0x21000
    s_nop 0
    buffer_load_dwordx4 v58, s[12:15], s72 offen lds
    v_add_u32 v9, 0x18000, v9
    v_add_u32 v10, 0x18000, v10
    ds_read_b64_tr_b16 v[80:81], v9 offset:0
    ds_read_b64_tr_b16 v[82:83], v9 offset:512
    ds_read_b64_tr_b16 v[84:85], v10 offset:0
    ds_read_b64_tr_b16 v[86:87], v10 offset:512
    ds_read_b64_tr_b16 v[88:89], v9 offset:2048
    ds_read_b64_tr_b16 v[90:91], v9 offset:2560
    ds_read_b64_tr_b16 v[92:93], v10 offset:2048
    ds_read_b64_tr_b16 v[94:95], v10 offset:2560
    ds_read_b64_tr_b16 v[96:97], v9 offset:4096
    ds_read_b64_tr_b16 v[98:99], v9 offset:4608
    ds_read_b64_tr_b16 v[100:101], v10 offset:4096
    ds_read_b64_tr_b16 v[102:103], v10 offset:4608
    ds_read_b64_tr_b16 v[104:105], v9 offset:6144
    ds_read_b64_tr_b16 v[106:107], v9 offset:6656
    ds_read_b64_tr_b16 v[108:109], v10 offset:6144
    ds_read_b64_tr_b16 v[110:111], v10 offset:6656
    s_waitcnt lgkmcnt(12)
    v_mfma_f32_32x32x16_bf16 v[16:31], v[80:83], v[128:131], 0
    v_mfma_f32_32x32x16_bf16 v[32:47], v[84:87], v[128:131], 0
    s_add_u32 m0, s48, 0x8000
    s_nop 0
    buffer_load_dwordx4 v3, s[12:15], s73 offen lds
    s_add_u32 m0, s48, 0x9000
    s_nop 0
    buffer_load_dwordx4 v58, s[12:15], s73 offen lds
    s_waitcnt lgkmcnt(8)
    v_mfma_f32_32x32x16_bf16 v[16:31], v[88:91], v[132:135], v[16:31]
    v_mfma_f32_32x32x16_bf16 v[32:47], v[92:95], v[132:135], v[32:47]
    s_add_u32 m0, s48, 0xa000
    s_nop 0
    buffer_load_dwordx4 v3, s[12:15], s74 offen lds
    s_add_u32 m0, s48, 0xb000
    s_nop 0
    buffer_load_dwordx4 v58, s[12:15], s74 offen lds
    s_waitcnt lgkmcnt(4)
    v_mfma_f32_32x32x16_bf16 v[16:31], v[96:99], v[136:139], v[16:31]
    v_mfma_f32_32x32x16_bf16 v[32:47], v[100:103], v[136:139], v[32:47]
    s_add_u32 m0, s48, 0xc000
    s_nop 0
    buffer_load_dwordx4 v3, s[12:15], s75 offen lds
    s_add_u32 m0, s48, 0xd000
    s_nop 0
    buffer_load_dwordx4 v58, s[12:15], s75 offen lds
    s_waitcnt lgkmcnt(0)
    v_mfma_f32_32x32x16_bf16 v[16:31], v[104:107], v[140:143], v[16:31]
    v_mfma_f32_32x32x16_bf16 v[32:47], v[108:111], v[140:143], v[32:47]
    s_add_u32 m0, s48, 0xe000
    s_nop 0
    buffer_load_dwordx4 v3, s[12:15], s76 offen lds
    s_add_u32 m0, s48, 0xf000
    s_nop 0
    buffer_load_dwordx4 v58, s[12:15], s76 offen lds
    ds_read_b64_tr_b16 v[72:73], v12 offset:0
    ds_read_b64_tr_b16 v[74:75], v12 offset:256
    ds_read_b64_tr_b16 v[64:65], v12 offset:1024
    ds_read_b64_tr_b16 v[66:67], v12 offset:1280
    buffer_store_dwordx4 v[48:51], v13, s[16:19], s56 offen offset:0 sc1
    buffer_store_dwordx4 v[48:51], v13, s[16:19], s56 offen offset:1024 sc1
    buffer_store_dwordx4 v[48:51], v13, s[16:19], s56 offen offset:2048 sc1
    buffer_store_dwordx4 v[48:51], v13, s[16:19], s56 offen offset:3072 sc1
    s_waitcnt vmcnt(14) lgkmcnt(0)
    s_barrier
    ds_read_b64_tr_b16 v[80:81], v9 offset:8192
    ds_read_b64_tr_b16 v[82:83], v9 offset:8704
    ds_read_b64_tr_b16 v[84:85], v10 offset:8192
    ds_read_b64_tr_b16 v[86:87], v10 offset:8704
    ds_read_b64_tr_b16 v[88:89], v9 offset:10240
    ds_read_b64_tr_b16 v[90:91], v9 offset:10752
    ds_read_b64_tr_b16 v[92:93], v10 offset:10240
    ds_read_b64_tr_b16 v[94:95], v10 offset:10752
    ds_read_b64_tr_b16 v[96:97], v9 offset:12288
    ds_read_b64_tr_b16 v[98:99], v9 offset:12800
    ds_read_b64_tr_b16 v[100:101], v10 offset:12288
    ds_read_b64_tr_b16 v[102:103], v10 offset:12800
    v_and_b32 v125, 4, v0
    v_cmp_eq_u32_e64 vcc, 0, v125
    s_nop 1
    v_cndmask_b32 v76, v72, 0, vcc
    v_cndmask_b32 v77, v73, 0, vcc
    v_cndmask_b32 v78, v74, 0, vcc
    v_cndmask_b32 v79, v75, 0, vcc
    v_cndmask_b32 v72, 0, v72, vcc
    v_cndmask_b32 v73, 0, v73, vcc
    v_cndmask_b32 v74, 0, v74, vcc
    v_cndmask_b32 v75, 0, v75, vcc
    v_and_b32 v125, 4, v0
    v_cmp_eq_u32_e64 vcc, 0, v125
    s_nop 1
    v_cndmask_b32 v68, v64, 0, vcc
    v_cndmask_b32 v69, v65, 0, vcc
    v_cndmask_b32 v70, v66, 0, vcc
    v_cndmask_b32 v71, v67, 0, vcc
    v_cndmask_b32 v64, 0, v64, vcc
    v_cndmask_b32 v65, 0, v65, vcc
    v_cndmask_b32 v66, 0, v66, vcc
    v_cndmask_b32_e64 v67, 0, v67, vcc
    s_waitcnt lgkmcnt(8)
    v_mfma_f32_32x32x16_bf16 v[16:31], v[80:83], v[144:147], v[16:31]
    ds_read_b64_tr_b16 v[104:105], v9 offset:14336
    ds_read_b64_tr_b16 v[106:107], v9 offset:14848
    v_mfma_f32_32x32x16_bf16 v[32:47], v[84:87], v[144:147], v[32:47]
    ds_read_b64_tr_b16 v[108:109], v10 offset:14336
    ds_read_b64_tr_b16 v[110:111], v10 offset:14848
    s_waitcnt lgkmcnt(8)
    v_mfma_f32_32x32x16_bf16 v[16:31], v[88:91], v[148:151], v[16:31]
    ds_read_b64_tr_b16 v[80:81], v9 offset:40960
    ds_read_b64_tr_b16 v[82:83], v9 offset:41472
    v_mfma_f32_32x32x16_bf16 v[32:47], v[92:95], v[148:151], v[32:47]
    ds_read_b64_tr_b16 v[84:85], v10 offset:40960
    ds_read_b64_tr_b16 v[86:87], v10 offset:41472
    s_waitcnt lgkmcnt(8)
    v_mfma_f32_32x32x16_bf16 v[16:31], v[96:99], v[152:155], v[16:31]
    ds_read_b64_tr_b16 v[88:89], v9 offset:43008
    ds_read_b64_tr_b16 v[90:91], v9 offset:43520
    v_mfma_f32_32x32x16_bf16 v[32:47], v[100:103], v[152:155], v[32:47]
    ds_read_b64_tr_b16 v[92:93], v10 offset:43008
    ds_read_b64_tr_b16 v[94:95], v10 offset:43520
    s_waitcnt lgkmcnt(8)
    v_mfma_f32_32x32x16_bf16 v[16:31], v[104:107], v[156:159], v[16:31]
    ds_read_b64_tr_b16 v[96:97], v9 offset:45056
    ds_read_b64_tr_b16 v[98:99], v9 offset:45568
    v_mfma_f32_32x32x16_bf16 v[32:47], v[108:111], v[156:159], v[32:47]
    ds_read_b64_tr_b16 v[100:101], v10 offset:45056
    ds_read_b64_tr_b16 v[102:103], v10 offset:45568
    s_waitcnt lgkmcnt(8)
    v_mfma_f32_32x32x16_bf16 v[16:31], v[80:83], v[160:163], v[16:31]
    ds_read_b64_tr_b16 v[104:105], v9 offset:47104
    ds_read_b64_tr_b16 v[106:107], v9 offset:47616
    v_mfma_f32_32x32x16_bf16 v[32:47], v[84:87], v[160:163], v[32:47]
    ds_read_b64_tr_b16 v[108:109], v10 offset:47104
    ds_read_b64_tr_b16 v[110:111], v10 offset:47616
    s_lshl_b32 s50, s41, 2
    s_and_b32 s51, s42, 3
    s_add_u32 s50, s50, s51
    s_lshl_b32 s50, s50, 2
    s_add_u32 s50, s50, s40
    s_lshl_b32 s50, s50, 11
    v_lshlrev_b32 v56, 7, v0
    s_mov_b64 exec, 0xffff
    s_bitcmp1_b32 s42, 2
    s_cbranch_scc1 L_mw_2_b
    buffer_load_dword v57, v56, s[20:23], s50 offen
    s_branch L_mw_2
L_mw_2_b:
    buffer_load_dword v57, v56, s[24:27], s50 offen
L_mw_2:
    s_mov_b64 exec, -1
    s_waitcnt lgkmcnt(8)
    v_mfma_f32_32x32x16_bf16 v[16:31], v[88:91], v[164:167], v[16:31]
    ds_read_b64_tr_b16 v[80:81], v9 offset:49152
    ds_read_b64_tr_b16 v[82:83], v9 offset:49664
    v_mfma_f32_32x32x16_bf16 v[32:47], v[92:95], v[164:167], v[32:47]
    ds_read_b64_tr_b16 v[84:85], v10 offset:49152
    ds_read_b64_tr_b16 v[86:87], v10 offset:49664
    s_waitcnt lgkmcnt(8)
    v_mfma_f32_32x32x16_bf16 v[16:31], v[96:99], v[168:171], v[16:31]
    ds_read_b64_tr_b16 v[88:89], v9 offset:51200
    ds_read_b64_tr_b16 v[90:91], v9 offset:51712
    v_mfma_f32_32x32x16_bf16 v[32:47], v[100:103], v[168:171], v[32:47]
    ds_read_b64_tr_b16 v[92:93], v10 offset:51200
    ds_read_b64_tr_b16 v[94:95], v10 offset:51712
    s_waitcnt lgkmcnt(8)
    v_mfma_f32_32x32x16_bf16 v[16:31], v[104:107], v[172:175], v[16:31]
    ds_read_b64_tr_b16 v[96:97], v9 offset:53248
    ds_read_b64_tr_b16 v[98:99], v9 offset:53760
    v_mfma_f32_32x32x16_bf16 v[32:47], v[108:111], v[172:175], v[32:47]
    ds_read_b64_tr_b16 v[100:101], v10 offset:53248
    ds_read_b64_tr_b16 v[102:103], v10 offset:53760
    s_waitcnt lgkmcnt(8)
    v_mfma_f32_32x32x16_bf16 v[16:31], v[80:83], v[176:179], v[16:31]
    ds_read_b64_tr_b16 v[104:105], v9 offset:55296
    ds_read_b64_tr_b16 v[106:107], v9 offset:55808
    v_mfma_f32_32x32x16_bf16 v[32:47], v[84:87], v[176:179], v[32:47]
    ds_read_b64_tr_b16 v[108:109], v10 offset:55296
    ds_read_b64_tr_b16 v[110:111], v10 offset:55808
    s_waitcnt lgkmcnt(8)
    v_mfma_f32_32x32x16_bf16 v[16:31], v[88:91], v[180:183], v[16:31]
    v_add_u32 v9, 0xfffe8000, v9
    v_add_u32 v10, 0xfffe8000, v10
    ds_read_b64_tr_b16 v[80:81], v9 offset:0
    ds_read_b64_tr_b16 v[82:83], v9 offset:512
    v_mfma_f32_32x32x16_bf16 v[32:47], v[92:95], v[180:183], v[32:47]
    ds_read_b64_tr_b16 v[84:85], v10 offset:0
    ds_read_b64_tr_b16 v[86:87], v10 offset:512
    s_waitcnt lgkmcnt(8)
    v_mfma_f32_32x32x16_bf16 v[16:31], v[96:99], v[184:187], v[16:31]
    ds_read_b64_tr_b16 v[88:89], v9 offset:2048
    ds_read_b64_tr_b16 v[90:91], v9 offset:2560
    v_mfma_f32_32x32x16_bf16 v[32:47], v[100:103], v[184:187], v[32:47]
    ds_read_b64_tr_b16 v[92:93], v10 offset:2048
    ds_read_b64_tr_b16 v[94:95], v10 offset:2560
    s_waitcnt lgkmcnt(8)
    v_mfma_f32_32x32x16_bf16 v[16:31], v[104:107], v[188:191], v[16:31]
    ds_read_b64_tr_b16 v[96:97], v9 offset:4096
    ds_read_b64_tr_b16 v[98:99], v9 offset:4608
    v_mfma_f32_32x32x16_bf16 v[32:47], v[108:111], v[188:191], v[32:47]
    ds_read_b64_tr_b16 v[100:101], v10 offset:4096
    ds_read_b64_tr_b16 v[102:103], v10 offset:4608
    s_waitcnt lgkmcnt(8)
    v_mfma_f32_32x32x16_bf16 v[16:31], v[80:83], v[192:195], v[16:31]
    ds_read_b64_tr_b16 v[104:105], v9 offset:6144
    ds_read_b64_tr_b16 v[106:107], v9 offset:6656
    v_mfma_f32_32x32x16_bf16 v[32:47], v[84:87], v[192:195], v[32:47]
    ds_read_b64_tr_b16 v[108:109], v10 offset:6144
    ds_read_b64_tr_b16 v[110:111], v10 offset:6656
    s_waitcnt lgkmcnt(8)
    v_mfma_f32_32x32x16_bf16 v[16:31], v[88:91], v[196:199], v[16:31]
    ds_read_b64_tr_b16 v[80:81], v9 offset:8192
    ds_read_b64_tr_b16 v[82:83], v9 offset:8704
    v_mfma_f32_32x32x16_bf16 v[32:47], v[92:95], v[196:199], v[32:47]
    ds_read_b64_tr_b16 v[84:85], v10 offset:8192
    ds_read_b64_tr_b16 v[86:87], v10 offset:8704
    s_waitcnt lgkmcnt(8)
    v_mfma_f32_32x32x16_bf16 v[16:31], v[96:99], v[200:203], v[16:31]
    ds_read_b64_tr_b16 v[88:89], v9 offset:10240
    ds_read_b64_tr_b16 v[90:91], v9 offset:10752
    v_mfma_f32_32x32x16_bf16 v[32:47], v[100:103], v[200:203], v[32:47]
    ds_read_b64_tr_b16 v[92:93], v10 offset:10240
    ds_read_b64_tr_b16 v[94:95], v10 offset:10752
    s_waitcnt lgkmcnt(8)
    v_mfma_f32_32x32x16_bf16 v[16:31], v[104:107], v[204:207], v[16:31]
    ds_read_b64_tr_b16 v[96:97], v9 offset:12288
    ds_read_b64_tr_b16 v[98:99], v9 offset:12800
    v_mfma_f32_32x32x16_bf16 v[32:47], v[108:111], v[204:207], v[32:47]
    ds_read_b64_tr_b16 v[100:101], v10 offset:12288
    ds_read_b64_tr_b16 v[102:103], v10 offset:12800
    s_waitcnt lgkmcnt(8)
    v_mfma_f32_32x32x16_bf16 v[16:31], v[80:83], v[208:211], v[16:31]
    ds_read_b64_tr_b16 v[104:105], v9 offset:14336
    ds_read_b64_tr_b16 v[106:107], v9 offset:14848
    v_mfma_f32_32x32x16_bf16 v[32:47], v[84:87], v[208:211], v[32:47]
    ds_read_b64_tr_b16 v[108:109], v10 offset:14336
    ds_read_b64_tr_b16 v[110:111], v10 offset:14848
    s_waitcnt lgkmcnt(8)
    v_mfma_f32_32x32x16_bf16 v[16:31], v[88:91], v[212:215], v[16:31]
    ds_read_b64_tr_b16 v[80:81], v9 offset:16384
    ds_read_b64_tr_b16 v[82:83], v9 offset:16896
    v_mfma_f32_32x32x16_bf16 v[32:47], v[92:95], v[212:215], v[32:47]
    ds_read_b64_tr_b16 v[84:85], v10 offset:16384
    ds_read_b64_tr_b16 v[86:87], v10 offset:16896
    s_waitcnt lgkmcnt(8)
    v_mfma_f32_32x32x16_bf16 v[16:31], v[96:99], v[216:219], v[16:31]
    ds_read_b64_tr_b16 v[88:89], v9 offset:18432
    ds_read_b64_tr_b16 v[90:91], v9 offset:18944
    v_mfma_f32_32x32x16_bf16 v[32:47], v[100:103], v[216:219], v[32:47]
    ds_read_b64_tr_b16 v[92:93], v10 offset:18432
    ds_read_b64_tr_b16 v[94:95], v10 offset:18944
    s_waitcnt lgkmcnt(8)
    v_mfma_f32_32x32x16_bf16 v[16:31], v[104:107], v[220:223], v[16:31]
    ds_read_b64_tr_b16 v[96:97], v9 offset:20480
    ds_read_b64_tr_b16 v[98:99], v9 offset:20992
    v_mfma_f32_32x32x16_bf16 v[32:47], v[108:111], v[220:223], v[32:47]
    ds_read_b64_tr_b16 v[100:101], v10 offset:20480
    ds_read_b64_tr_b16 v[102:103], v10 offset:20992
    s_waitcnt lgkmcnt(8)
    v_mfma_f32_32x32x16_bf16 v[16:31], v[80:83], v[224:227], v[16:31]
    ds_read_b64_tr_b16 v[104:105], v9 offset:22528
    ds_read_b64_tr_b16 v[106:107], v9 offset:23040
    v_mfma_f32_32x32x16_bf16 v[32:47], v[84:87], v[224:227], v[32:47]
    ds_read_b64_tr_b16 v[108:109], v10 offset:22528
    ds_read_b64_tr_b16 v[110:111], v10 offset:23040
    s_waitcnt lgkmcnt(8)
    v_mfma_f32_32x32x16_bf16 v[16:31], v[88:91], v[228:231], v[16:31]
    ds_read_b64_tr_b16 v[80:81], v9 offset:24576
    ds_read_b64_tr_b16 v[82:83], v9 offset:25088
    v_mfma_f32_32x32x16_bf16 v[32:47], v[92:95], v[228:231], v[32:47]
    ds_read_b64_tr_b16 v[84:85], v10 offset:24576
    ds_read_b64_tr_b16 v[86:87], v10 offset:25088
    s_waitcnt lgkmcnt(8)
    v_mfma_f32_32x32x16_bf16 v[16:31], v[96:99], v[232:235], v[16:31]
    ds_read_b64_tr_b16 v[88:89], v9 offset:26624
    ds_read_b64_tr_b16 v[90:91], v9 offset:27136
    v_mfma_f32_32x32x16_bf16 v[32:47], v[100:103], v[232:235], v[32:47]
    ds_read_b64_tr_b16 v[92:93], v10 offset:26624
    ds_read_b64_tr_b16 v[94:95], v10 offset:27136
    s_waitcnt lgkmcnt(8)
    v_mfma_f32_32x32x16_bf16 v[16:31], v[104:107], v[236:239], v[16:31]
    ds_read_b64_tr_b16 v[96:97], v9 offset:28672
    ds_read_b64_tr_b16 v[98:99], v9 offset:29184
    v_mfma_f32_32x32x16_bf16 v[32:47], v[108:111], v[236:239], v[32:47]
    ds_read_b64_tr_b16 v[100:101], v10 offset:28672
    ds_read_b64_tr_b16 v[102:103], v10 offset:29184
    s_waitcnt lgkmcnt(8)
    v_mfma_f32_32x32x16_bf16 v[16:31], v[80:83], v[240:243], v[16:31]
    ds_read_b64_tr_b16 v[104:105], v9 offset:30720
    ds_read_b64_tr_b16 v[106:107], v9 offset:31232
    v_mfma_f32_32x32x16_bf16 v[32:47], v[84:87], v[240:243], v[32:47]
    ds_read_b64_tr_b16 v[108:109], v10 offset:30720
    ds_read_b64_tr_b16 v[110:111], v10 offset:31232
    s_waitcnt lgkmcnt(8)
    v_mfma_f32_32x32x16_bf16 v[16:31], v[88:91], v[244:247], v[16:31]
    s_waitcnt lgkmcnt(4)
    v_mfma_f32_32x32x16_bf16 v[16:31], v[96:99], v[248:251], v[16:31]
    s_waitcnt lgkmcnt(0)
    v_mfma_f32_32x32x16_bf16 v[16:31], v[104:107], v[252:255], v[16:31]
    v_mfma_f32_32x32x16_bf16 v[32:47], v[92:95], v[244:247], v[32:47]
    v_mfma_f32_32x32x16_bf16 v[32:47], v[100:103], v[248:251], v[32:47]
    s_nop 9
    v_cvt_pk_bf16_f32 v16, v16, v17
    v_cvt_pk_bf16_f32 v17, v18, v19
    v_cvt_pk_bf16_f32 v18, v20, v21
    v_cvt_pk_bf16_f32 v19, v22, v23
    v_mfma_f32_32x32x16_bf16 v[32:47], v[108:111], v[252:255], v[32:47]
    ds_write_b128 v116, v[16:19] offset:0
    v_cvt_pk_bf16_f32 v20, v24, v25
    v_cvt_pk_bf16_f32 v21, v26, v27
    v_cvt_pk_bf16_f32 v22, v28, v29
    v_cvt_pk_bf16_f32 v23, v30, v31
    ds_write_b128 v117, v[20:23] offset:0
    s_nop 5
    v_cvt_pk_bf16_f32 v32, v32, v33
    v_cvt_pk_bf16_f32 v33, v34, v35
    v_cvt_pk_bf16_f32 v34, v36, v37
    v_cvt_pk_bf16_f32 v35, v38, v39
    ds_write_b128 v116, v[32:35] offset:8192
    v_cvt_pk_bf16_f32 v36, v40, v41
    v_cvt_pk_bf16_f32 v37, v42, v43
    v_cvt_pk_bf16_f32 v38, v44, v45
    v_cvt_pk_bf16_f32 v39, v46, v47
    ds_write_b128 v117, v[36:39] offset:8192
    s_waitcnt vmcnt(5) lgkmcnt(0)
    s_barrier
    s_add_u32 m0, s48, 0x6000
    s_nop 0
    buffer_load_dwordx4 v3, s[12:15], s77 offen lds
    s_add_u32 m0, s48, 0x7000
    s_nop 0
    buffer_load_dwordx4 v58, s[12:15], s77 offen lds
    s_add_u32 m0, s48, 0x22000
    s_nop 0
    buffer_load_dwordx4 v3, s[12:15], s78 offen lds
    s_add_u32 m0, s48, 0x23000
    s_nop 0
    buffer_load_dwordx4 v58, s[12:15], s78 offen lds
    s_add_u32 m0, s48, 0x24000
    s_nop 0
    buffer_load_dwordx4 v3, s[12:15], s79 offen lds
    s_add_u32 m0, s48, 0x25000
    s_nop 0
    buffer_load_dwordx4 v58, s[12:15], s79 offen lds
    buffer_load_dwordx2 v[14:15], off, s[36:39], 0 sc1
L_TA0_0:
    s_cbranch_execz L_TA0_1
    s_nop 0
    s_and_b32 s79, s40, 1
    s_bfe_u32 s77, s40, 0x10001
    s_lshl_b32 s78, s45, 1
    s_add_u32 s78, s78, s79
    s_lshl_b32 s50, s78, 2
    s_lshr_b32 s51, s40, 1
    s_add_u32 s50, s50, s51
    s_lshl_b32 s50, s50, 14
    s_lshr_b32 s51, s80, 16
    s_lshl_b32 s51, s51, 12
    s_add_u32 s72, s50, s51
    s_lshr_b32 s51, s81, 16
    s_lshl_b32 s51, s51, 12
    s_add_u32 s73, s50, s51
    s_lshr_b32 s51, s82, 16
    s_lshl_b32 s51, s51, 12
    s_add_u32 s74, s50, s51
    s_lshr_b32 s51, s83, 16
    s_lshl_b32 s51, s51, 12
    s_add_u32 s75, s50, s51
    s_lshl_b32 s68, s78, 12
    s_lshl_b32 s50, s85, 18
    s_add_u32 s68, s68, s50
    s_add_u32 s68, s68, 0x560000
    s_lshl_b32 s76, s45, 6
    s_and_b32 s50, s40, 6
    s_lshl_b32 s50, s50, 3
    s_add_u32 s76, s76, s50
    s_add_u32 s76, s76, s79
    s_lshl_b32 s76, s76, 10
    s_lshl_b32 s50, s46, 7
    s_add_u32 s76, s76, s50
    v_add_u32 v9, 0x18000, v9
    v_add_u32 v10, 0x18000, v10
    ds_read_b64_tr_b16 v[80:81], v9 offset:32768
    ds_read_b64_tr_b16 v[82:83], v9 offset:33280
    ds_read_b64_tr_b16 v[84:85], v10 offset:32768
    ds_read_b64_tr_b16 v[86:87], v10 offset:33280
    ds_read_b64_tr_b16 v[88:89], v9 offset:34816
    ds_read_b64_tr_b16 v[90:91], v9 offset:35328
    ds_read_b64_tr_b16 v[92:93], v10 offset:34816
    ds_read_b64_tr_b16 v[94:95], v10 offset:35328
    ds_read_b64_tr_b16 v[96:97], v9 offset:36864
    ds_read_b64_tr_b16 v[98:99], v9 offset:37376
    ds_read_b64_tr_b16 v[100:101], v10 offset:36864
    ds_read_b64_tr_b16 v[102:103], v10 offset:37376
    s_waitcnt lgkmcnt(8)
    v_mfma_f32_32x32x16_bf16 v[16:31], v[80:83], v[128:131], 0
    ds_read_b64_tr_b16 v[104:105], v9 offset:38912
    ds_read_b64_tr_b16 v[106:107], v9 offset:39424
    v_mfma_f32_32x32x16_bf16 v[32:47], v[84:87], v[128:131], 0
    ds_read_b64_tr_b16 v[108:109], v10 offset:38912
    ds_read_b64_tr_b16 v[110:111], v10 offset:39424
    s_waitcnt lgkmcnt(8)
    v_mfma_f32_32x32x16_bf16 v[16:31], v[88:91], v[132:135], v[16:31]
    v_add_u32 v9, 0xfffe8000, v9
    v_add_u32 v10, 0xfffe8000, v10
    ds_read_b64_tr_b16 v[80:81], v9 offset:32768
    ds_read_b64_tr_b16 v[82:83], v9 offset:33280
    v_mfma_f32_32x32x16_bf16 v[32:47], v[92:95], v[132:135], v[32:47]
    ds_read_b64_tr_b16 v[84:85], v10 offset:32768
    ds_read_b64_tr_b16 v[86:87], v10 offset:33280
    s_waitcnt lgkmcnt(8)
    v_mfma_f32_32x32x16_bf16 v[16:31], v[96:99], v[136:139], v[16:31]
    ds_read_b64_tr_b16 v[88:89], v9 offset:34816
    ds_read_b64_tr_b16 v[90:91], v9 offset:35328
    v_mfma_f32_32x32x16_bf16 v[32:47], v[100:103], v[136:139], v[32:47]
    ds_read_b64_tr_b16 v[92:93], v10 offset:34816
    ds_read_b64_tr_b16 v[94:95], v10 offset:35328
    s_waitcnt lgkmcnt(8)
    v_mfma_f32_32x32x16_bf16 v[16:31], v[104:107], v[140:143], v[16:31]
    ds_read_b64_tr_b16 v[96:97], v9 offset:36864
    ds_read_b64_tr_b16 v[98:99], v9 offset:37376
    v_mfma_f32_32x32x16_bf16 v[32:47], v[108:111], v[140:143], v[32:47]
    ds_read_b64_tr_b16 v[100:101], v10 offset:36864
    ds_read_b64_tr_b16 v[102:103], v10 offset:37376
    s_waitcnt lgkmcnt(8)
    v_mfma_f32_32x32x16_bf16 v[16:31], v[80:83], v[144:147], v[16:31]
    ds_read_b64_tr_b16 v[104:105], v9 offset:38912
    ds_read_b64_tr_b16 v[106:107], v9 offset:39424
    v_mfma_f32_32x32x16_bf16 v[32:47], v[84:87], v[144:147], v[32:47]
    ds_read_b64_tr_b16 v[108:109], v10 offset:38912
    ds_read_b64_tr_b16 v[110:111], v10 offset:39424
    s_waitcnt lgkmcnt(8)
    v_mfma_f32_32x32x16_bf16 v[16:31], v[88:91], v[148:151], v[16:31]
    ds_read_b64_tr_b16 v[80:81], v9 offset:40960
    ds_read_b64_tr_b16 v[82:83], v9 offset:41472
    v_mfma_f32_32x32x16_bf16 v[32:47], v[92:95], v[148:151], v[32:47]
    ds_read_b64_tr_b16 v[84:85], v10 offset:40960
    ds_read_b64_tr_b16 v[86:87], v10 offset:41472
    s_waitcnt lgkmcnt(8)
    v_mfma_f32_32x32x16_bf16 v[16:31], v[96:99], v[152:155], v[16:31]
    ds_read_b64_tr_b16 v[88:89], v9 offset:43008
    ds_read_b64_tr_b16 v[90:91], v9 offset:43520
    v_mfma_f32_32x32x16_bf16 v[32:47], v[100:103], v[152:155], v[32:47]
    ds_read_b64_tr_b16 v[92:93], v10 offset:43008
    ds_read_b64_tr_b16 v[94:95], v10 offset:43520
    s_waitcnt vmcnt(1)
    s_mov_b64 exec, 1
    ds_add_u32 v126, v127 offset:8
    s_mov_b64 exec, -1
    s_waitcnt lgkmcnt(9)
    v_mfma_f32_32x32x16_bf16 v[16:31], v[104:107], v[156:159], v[16:31]
    ds_read_b64_tr_b16 v[96:97], v9 offset:45056
    ds_read_b64_tr_b16 v[98:99], v9 offset:45568
    v_mfma_f32_32x32x16_bf16 v[32:47], v[108:111], v[156:159], v[32:47]
    ds_read_b64_tr_b16 v[100:101], v10 offset:45056
    ds_read_b64_tr_b16 v[102:103], v10 offset:45568
    s_waitcnt lgkmcnt(9)
    v_mfma_f32_32x32x16_bf16 v[16:31], v[80:83], v[160:163], v[16:31]
    ds_read_b64_tr_b16 v[104:105], v9 offset:47104
    ds_read_b64_tr_b16 v[106:107], v9 offset:47616
    v_mfma_f32_32x32x16_bf16 v[32:47], v[84:87], v[160:163], v[32:47]
    ds_read_b64_tr_b16 v[108:109], v10 offset:47104
    ds_read_b64_tr_b16 v[110:111], v10 offset:47616
    s_waitcnt lgkmcnt(9)
    v_mfma_f32_32x32x16_bf16 v[16:31], v[88:91], v[164:167], v[16:31]
    ds_read_b64_tr_b16 v[80:81], v9 offset:49152
    ds_read_b64_tr_b16 v[82:83], v9 offset:49664
    v_mfma_f32_32x32x16_bf16 v[32:47], v[92:95], v[164:167], v[32:47]
    ds_read_b64_tr_b16 v[84:85], v10 offset:49152
    ds_read_b64_tr_b16 v[86:87], v10 offset:49664
    s_waitcnt lgkmcnt(8)
    v_mfma_f32_32x32x16_bf16 v[16:31], v[96:99], v[168:171], v[16:31]
    ds_read_b64_tr_b16 v[88:89], v9 offset:51200
    ds_read_b64_tr_b16 v[90:91], v9 offset:51712
    v_mfma_f32_32x32x16_bf16 v[32:47], v[100:103], v[168:171], v[32:47]
    ds_read_b64_tr_b16 v[92:93], v10 offset:51200
    ds_read_b64_tr_b16 v[94:95], v10 offset:51712
    s_waitcnt lgkmcnt(8)
    v_mfma_f32_32x32x16_bf16 v[16:31], v[104:107], v[172:175], v[16:31]
    ds_read_b64_tr_b16 v[96:97], v9 offset:53248
    ds_read_b64_tr_b16 v[98:99], v9 offset:53760
    v_mfma_f32_32x32x16_bf16 v[32:47], v[108:111], v[172:175], v[32:47]
    ds_read_b64_tr_b16 v[100:101], v10 offset:53248
    ds_read_b64_tr_b16 v[102:103], v10 offset:53760
    s_waitcnt lgkmcnt(8)
    v_mfma_f32_32x32x16_bf16 v[16:31], v[80:83], v[176:179], v[16:31]
    ds_read_b64_tr_b16 v[104:105], v9 offset:55296
    ds_read_b64_tr_b16 v[106:107], v9 offset:55808
    v_mfma_f32_32x32x16_bf16 v[32:47], v[84:87], v[176:179], v[32:47]
    ds_read_b64_tr_b16 v[108:109], v10 offset:55296
    ds_read_b64_tr_b16 v[110:111], v10 offset:55808
    s_waitcnt lgkmcnt(8)
    v_mfma_f32_32x32x16_bf16 v[16:31], v[88:91], v[180:183], v[16:31]
    ds_read_b64_tr_b16 v[80:81], v9 offset:57344
    ds_read_b64_tr_b16 v[82:83], v9 offset:57856
    v_mfma_f32_32x32x16_bf16 v[32:47], v[92:95], v[180:183], v[32:47]
    ds_read_b64_tr_b16 v[84:85], v10 offset:57344
    ds_read_b64_tr_b16 v[86:87], v10 offset:57856
    s_waitcnt lgkmcnt(8)
    v_mfma_f32_32x32x16_bf16 v[16:31], v[96:99], v[184:187], v[16:31]
    ds_read_b64_tr_b16 v[88:89], v9 offset:59392
    ds_read_b64_tr_b16 v[90:91], v9 offset:59904
    v_mfma_f32_32x32x16_bf16 v[32:47], v[100:103], v[184:187], v[32:47]
    ds_read_b64_tr_b16 v[92:93], v10 offset:59392
    ds_read_b64_tr_b16 v[94:95], v10 offset:59904
    ds_read_b32 v125, v126 offset:8
    s_waitcnt lgkmcnt(9)
    v_mfma_f32_32x32x16_bf16 v[16:31], v[104:107], v[188:191], v[16:31]
    ds_read_b64_tr_b16 v[96:97], v9 offset:61440
    ds_read_b64_tr_b16 v[98:99], v9 offset:61952
    v_mfma_f32_32x32x16_bf16 v[32:47], v[108:111], v[188:191], v[32:47]
    ds_read_b64_tr_b16 v[100:101], v10 offset:61440
    ds_read_b64_tr_b16 v[102:103], v10 offset:61952
    s_waitcnt lgkmcnt(9)
    v_mfma_f32_32x32x16_bf16 v[16:31], v[80:83], v[192:195], v[16:31]
    ds_read_b64_tr_b16 v[104:105], v9 offset:63488
    ds_read_b64_tr_b16 v[106:107], v9 offset:64000
    v_mfma_f32_32x32x16_bf16 v[32:47], v[84:87], v[192:195], v[32:47]
    ds_read_b64_tr_b16 v[108:109], v10 offset:63488
    ds_read_b64_tr_b16 v[110:111], v10 offset:64000
    s_waitcnt lgkmcnt(9)
    v_mfma_f32_32x32x16_bf16 v[16:31], v[88:91], v[196:199], v[16:31]
    s_waitcnt lgkmcnt(8)
    v_readfirstlane_b32 s50, v125
    s_cmp_lt_u32 s50, 4
    s_cbranch_scc0 L_o_3
L_o_3_r:
    ds_read_b32 v125, v126 offset:8
    s_waitcnt lgkmcnt(0)
    v_readfirstlane_b32 s50, v125
    s_cmp_lt_u32 s50, 4
    s_cbranch_scc1 L_o_3_r
L_o_3:
    ds_read_b64_tr_b16 v[80:81], v9 offset:24576
    ds_read_b64_tr_b16 v[82:83], v9 offset:25088
    v_mfma_f32_32x32x16_bf16 v[32:47], v[92:95], v[196:199], v[32:47]
    ds_read_b64_tr_b16 v[84:85], v10 offset:24576
    ds_read_b64_tr_b16 v[86:87], v10 offset:25088
    s_waitcnt lgkmcnt(8)
    v_mfma_f32_32x32x16_bf16 v[16:31], v[96:99], v[200:203], v[16:31]
    ds_read_b64_tr_b16 v[88:89], v9 offset:26624
    ds_read_b64_tr_b16 v[90:91], v9 offset:27136
    v_mfma_f32_32x32x16_bf16 v[32:47], v[100:103], v[200:203], v[32:47]
    ds_read_b64_tr_b16 v[92:93], v10 offset:26624
    ds_read_b64_tr_b16 v[94:95], v10 offset:27136
    s_waitcnt lgkmcnt(8)
    v_mfma_f32_32x32x16_bf16 v[16:31], v[104:107], v[204:207], v[16:31]
    ds_read_b64_tr_b16 v[96:97], v9 offset:28672
    ds_read_b64_tr_b16 v[98:99], v9 offset:29184
    v_mfma_f32_32x32x16_bf16 v[32:47], v[108:111], v[204:207], v[32:47]
    ds_read_b64_tr_b16 v[100:101], v10 offset:28672
    ds_read_b64_tr_b16 v[102:103], v10 offset:29184
    s_waitcnt lgkmcnt(8)
    v_mfma_f32_32x32x16_bf16 v[16:31], v[80:83], v[208:211], v[16:31]
    ds_read_b64_tr_b16 v[104:105], v9 offset:30720
    ds_read_b64_tr_b16 v[106:107], v9 offset:31232
    v_mfma_f32_32x32x16_bf16 v[32:47], v[84:87], v[208:211], v[32:47]
    ds_read_b64_tr_b16 v[108:109], v10 offset:30720
    ds_read_b64_tr_b16 v[110:111], v10 offset:31232
    s_waitcnt lgkmcnt(8)
    v_mfma_f32_32x32x16_bf16 v[16:31], v[88:91], v[212:215], v[16:31]
    v_add_u32 v9, 0x18000, v9
    v_add_u32 v10, 0x18000, v10
    ds_read_b64_tr_b16 v[80:81], v9 offset:40960
    ds_read_b64_tr_b16 v[82:83], v9 offset:41472
    v_mfma_f32_32x32x16_bf16 v[32:47], v[92:95], v[212:215], v[32:47]
    ds_read_b64_tr_b16 v[84:85], v10 offset:40960
    ds_read_b64_tr_b16 v[86:87], v10 offset:41472
    s_waitcnt lgkmcnt(8)
    v_mfma_f32_32x32x16_bf16 v[16:31], v[96:99], v[216:219], v[16:31]
    ds_read_b64_tr_b16 v[88:89], v9 offset:43008
    ds_read_b64_tr_b16 v[90:91], v9 offset:43520
    v_mfma_f32_32x32x16_bf16 v[32:47], v[100:103], v[216:219], v[32:47]
    ds_read_b64_tr_b16 v[92:93], v10 offset:43008
    ds_read_b64_tr_b16 v[94:95], v10 offset:43520
    s_waitcnt lgkmcnt(8)
    v_mfma_f32_32x32x16_bf16 v[16:31], v[104:107], v[220:223], v[16:31]
    ds_read_b64_tr_b16 v[96:97], v9 offset:45056
    ds_read_b64_tr_b16 v[98:99], v9 offset:45568
    v_mfma_f32_32x32x16_bf16 v[32:47], v[108:111], v[220:223], v[32:47]
    ds_read_b64_tr_b16 v[100:101], v10 offset:45056
    ds_read_b64_tr_b16 v[102:103], v10 offset:45568
    s_waitcnt lgkmcnt(8)
    v_mfma_f32_32x32x16_bf16 v[16:31], v[80:83], v[224:227], v[16:31]
    ds_read_b64_tr_b16 v[104:105], v9 offset:47104
    ds_read_b64_tr_b16 v[106:107], v9 offset:47616
    v_mfma_f32_32x32x16_bf16 v[32:47], v[84:87], v[224:227], v[32:47]
    ds_read_b64_tr_b16 v[108:109], v10 offset:47104
    ds_read_b64_tr_b16 v[110:111], v10 offset:47616
    s_waitcnt lgkmcnt(8)
    v_mfma_f32_32x32x16_bf16 v[16:31], v[88:91], v[228:231], v[16:31]
    ds_read_b64_tr_b16 v[80:81], v9 offset:49152
    ds_read_b64_tr_b16 v[82:83], v9 offset:49664
    v_mfma_f32_32x32x16_bf16 v[32:47], v[92:95], v[228:231], v[32:47]
    ds_read_b64_tr_b16 v[84:85], v10 offset:49152
    ds_read_b64_tr_b16 v[86:87], v10 offset:49664
    s_waitcnt lgkmcnt(8)
    v_mfma_f32_32x32x16_bf16 v[16:31], v[96:99], v[232:235], v[16:31]
    ds_read_b64_tr_b16 v[88:89], v9 offset:51200
    ds_read_b64_tr_b16 v[90:91], v9 offset:51712
    v_mfma_f32_32x32x16_bf16 v[32:47], v[100:103], v[232:235], v[32:47]
    ds_read_b64_tr_b16 v[92:93], v10 offset:51200
    ds_read_b64_tr_b16 v[94:95], v10 offset:51712
    s_waitcnt lgkmcnt(8)
    v_mfma_f32_32x32x16_bf16 v[16:31], v[104:107], v[236:239], v[16:31]
    ds_read_b64_tr_b16 v[96:97], v9 offset:53248
    ds_read_b64_tr_b16 v[98:99], v9 offset:53760
    v_mfma_f32_32x32x16_bf16 v[32:47], v[108:111], v[236:239], v[32:47]
    ds_read_b64_tr_b16 v[100:101], v10 offset:53248
    ds_read_b64_tr_b16 v[102:103], v10 offset:53760
    s_waitcnt lgkmcnt(8)
    v_mfma_f32_32x32x16_bf16 v[16:31], v[80:83], v[240:243], v[16:31]
    ds_read_b64_tr_b16 v[104:105], v9 offset:55296
    ds_read_b64_tr_b16 v[106:107], v9 offset:55808
    v_mfma_f32_32x32x16_bf16 v[32:47], v[84:87], v[240:243], v[32:47]
    ds_read_b64_tr_b16 v[108:109], v10 offset:55296
    ds_read_b64_tr_b16 v[110:111], v10 offset:55808
    s_waitcnt lgkmcnt(8)
    v_mfma_f32_32x32x16_bf16 v[16:31], v[88:91], v[244:247], v[16:31]
    v_mfma_f32_32x32x16_bf16 v[32:47], v[92:95], v[244:247], v[32:47]
    s_waitcnt lgkmcnt(4)
    v_mfma_f32_32x32x16_bf16 v[16:31], v[96:99], v[248:251], v[16:31]
    v_mfma_f32_32x32x16_bf16 v[32:47], v[100:103], v[248:251], v[32:47]
    s_waitcnt lgkmcnt(0)
    v_mfma_f32_32x32x16_bf16 v[16:31], v[104:107], v[252:255], v[16:31]
    v_mfma_f32_32x32x16_bf16 v[32:47], v[108:111], v[252:255], v[32:47]
    s_mov_b64 exec, 1
    ds_add_u32 v126, v127 offset:0
    s_mov_b64 exec, -1
    ds_read_b32 v125, v126 offset:0
    s_waitcnt vmcnt(0)
    s_mov_b32 s51, 0
    v_readfirstlane_b32 s50, v15
    v_readfirstlane_b32 s47, v14
    s_cmp_eq_u32 s50, 0
    s_cbranch_scc0 L_o_4
L_o_4_r:
    s_add_u32 s51, s51, 1
    s_cmp_gt_u32 s51, 0x10000
    s_cbranch_scc1 L_o_4
    s_sleep 4
    buffer_load_dwordx2 v[14:15], off, s[36:39], 0 sc1
    s_waitcnt vmcnt(0)
    v_readfirstlane_b32 s50, v15
    v_readfirstlane_b32 s47, v14
    s_cmp_eq_u32 s50, 0
    s_cbranch_scc1 L_o_4_r
L_o_4:
    v_lshlrev_b32 v15, 2, v0
    v_cvt_pk_bf16_f32 v80, v16, v17
    v_cvt_pk_bf16_f32 v81, v18, v19
    v_cvt_pk_bf16_f32 v82, v20, v21
    v_cvt_pk_bf16_f32 v83, v22, v23
    v_cvt_pk_bf16_f32 v84, v24, v25
    v_cvt_pk_bf16_f32 v85, v26, v27
    v_cvt_pk_bf16_f32 v86, v28, v29
    v_cvt_pk_bf16_f32 v87, v30, v31
    v_mfma_f32_32x32x16_bf16 v[16:31], v[72:75], v[80:83], 0
    s_nop 0
    v_mfma_f32_32x32x16_bf16 v[16:31], v[76:79], v[84:87], v[16:31]
    v_cvt_pk_bf16_f32 v48, v32, v33
    v_cvt_pk_bf16_f32 v49, v34, v35
    v_cvt_pk_bf16_f32 v50, v36, v37
    v_cvt_pk_bf16_f32 v51, v38, v39
    v_cvt_pk_bf16_f32 v52, v40, v41
    v_cvt_pk_bf16_f32 v53, v42, v43
    v_cvt_pk_bf16_f32 v54, v44, v45
    v_cvt_pk_bf16_f32 v55, v46, v47
    v_mfma_f32_32x32x16_bf16 v[32:47], v[64:67], v[48:51], 0
    s_nop 0
    v_mfma_f32_32x32x16_bf16 v[32:47], v[68:71], v[52:55], v[32:47]
    s_waitcnt lgkmcnt(0)
    v_readfirstlane_b32 s50, v125
    s_cmp_lt_u32 s50, 4
    s_cbranch_scc0 L_o_5
L_o_5_r:
    ds_read_b32 v125, v126 offset:0
    s_waitcnt lgkmcnt(0)
    v_readfirstlane_b32 s50, v125
    s_cmp_lt_u32 s50, 4
    s_cbranch_scc1 L_o_5_r
L_o_5:
    s_add_u32 m0, s48, 0xa000
    s_add_u32 s49, s81, 0x40000
    buffer_load_dwordx4 v4, s[20:23], s49 offen lds
    s_add_u32 m0, s48, 0xb000
    s_add_u32 s49, s81, 0x40000
    buffer_load_dwordx4 v124, s[20:23], s49 offen lds
    s_add_u32 m0, s48, 0xc000
    s_add_u32 s49, s82, 0x40000
    buffer_load_dwordx4 v4, s[20:23], s49 offen lds
    s_add_u32 m0, s48, 0xd000
    s_add_u32 s49, s82, 0x40000
    buffer_load_dwordx4 v124, s[20:23], s49 offen lds
    s_add_u32 m0, s48, 0xe000
    s_add_u32 s49, s83, 0x40000
    buffer_load_dwordx4 v4, s[20:23], s49 offen lds
    s_add_u32 m0, s48, 0xf000
    s_add_u32 s49, s83, 0x40000
    buffer_load_dwordx4 v124, s[20:23], s49 offen lds
    v_max3_f32 v104, v16, v17, v18
    v_max3_f32 v105, v19, v20, v21
    v_min3_f32 v106, v16, v17, v18
    v_min3_f32 v107, v19, v20, v21
    v_max3_f32 v104, v104, v22, v23
    v_max3_f32 v105, v105, v24, v25
    v_min3_f32 v106, v106, v22, v23
    v_min3_f32 v107, v107, v24, v25
    v_max3_f32 v104, v104, v26, v27
    v_max3_f32 v105, v105, v28, v29
    v_min3_f32 v106, v106, v26, v27
    v_min3_f32 v107, v107, v28, v29
    v_max3_f32 v104, v104, v30, v31
    v_min3_f32 v106, v106, v30, v31
    v_max_f32 v104, v104, v105
    v_min_f32 v106, v106, v107
    v_mul_f32 v104, s52, v104
    v_mul_f32 v106, s52, v106
    v_pk_fma_f32 v[88:89], v[16:17], s[52:53], v[104:105] op_sel_hi:[1,1,0] neg_lo:[0,0,1] neg_hi:[0,0,1]
    v_pk_fma_f32 v[90:91], v[18:19], s[52:53], v[104:105] op_sel_hi:[1,1,0] neg_lo:[0,0,1] neg_hi:[0,0,1]
    v_pk_fma_f32 v[92:93], v[20:21], s[52:53], v[104:105] op_sel_hi:[1,1,0] neg_lo:[0,0,1] neg_hi:[0,0,1]
    v_pk_fma_f32 v[94:95], v[22:23], s[52:53], v[104:105] op_sel_hi:[1,1,0] neg_lo:[0,0,1] neg_hi:[0,0,1]
    v_pk_fma_f32 v[96:97], v[24:25], s[52:53], v[104:105] op_sel_hi:[1,1,0] neg_lo:[0,0,1] neg_hi:[0,0,1]
    v_pk_fma_f32 v[98:99], v[26:27], s[52:53], v[104:105] op_sel_hi:[1,1,0] neg_lo:[0,0,1] neg_hi:[0,0,1]
    v_pk_fma_f32 v[100:101], v[28:29], s[52:53], v[104:105] op_sel_hi:[1,1,0] neg_lo:[0,0,1] neg_hi:[0,0,1]
    v_pk_fma_f32 v[102:103], v[30:31], s[52:53], v[104:105] op_sel_hi:[1,1,0] neg_lo:[0,0,1] neg_hi:[0,0,1]
    v_pk_fma_f32 v[16:17], v[16:17], s[52:53], v[106:107] op_sel_hi:[1,1,0] neg_lo:[1,0,0] neg_hi:[1,0,0]
    v_pk_fma_f32 v[18:19], v[18:19], s[52:53], v[106:107] op_sel_hi:[1,1,0] neg_lo:[1,0,0] neg_hi:[1,0,0]
    v_pk_fma_f32 v[20:21], v[20:21], s[52:53], v[106:107] op_sel_hi:[1,1,0] neg_lo:[1,0,0] neg_hi:[1,0,0]
    v_pk_fma_f32 v[22:23], v[22:23], s[52:53], v[106:107] op_sel_hi:[1,1,0] neg_lo:[1,0,0] neg_hi:[1,0,0]
    v_pk_fma_f32 v[24:25], v[24:25], s[52:53], v[106:107] op_sel_hi:[1,1,0] neg_lo:[1,0,0] neg_hi:[1,0,0]
    v_pk_fma_f32 v[26:27], v[26:27], s[52:53], v[106:107] op_sel_hi:[1,1,0] neg_lo:[1,0,0] neg_hi:[1,0,0]
    v_pk_fma_f32 v[28:29], v[28:29], s[52:53], v[106:107] op_sel_hi:[1,1,0] neg_lo:[1,0,0] neg_hi:[1,0,0]
    v_pk_fma_f32 v[30:31], v[30:31], s[52:53], v[106:107] op_sel_hi:[1,1,0] neg_lo:[1,0,0] neg_hi:[1,0,0]
    v_exp_f32 v88, v88
    v_exp_f32 v89, v89
    v_exp_f32 v90, v90
    v_exp_f32 v91, v91
    v_exp_f32 v92, v92
    v_exp_f32 v93, v93
    v_exp_f32 v94, v94
    v_exp_f32 v95, v95
    v_exp_f32 v96, v96
    v_exp_f32 v97, v97
    v_exp_f32 v98, v98
    v_exp_f32 v99, v99
    v_exp_f32 v100, v100
    v_exp_f32 v101, v101
    v_exp_f32 v102, v102
    v_exp_f32 v103, v103
    v_exp_f32 v16, v16
    v_exp_f32 v17, v17
    v_exp_f32 v18, v18
    v_exp_f32 v19, v19
    v_exp_f32 v20, v20
    v_exp_f32 v21, v21
    v_exp_f32 v22, v22
    v_exp_f32 v23, v23
    v_exp_f32 v24, v24
    v_exp_f32 v25, v25
    v_exp_f32 v26, v26
    v_exp_f32 v27, v27
    v_exp_f32 v28, v28
    v_exp_f32 v29, v29
    v_exp_f32 v30, v30
    v_exp_f32 v31, v31
    v_pk_add_f32 v[80:81], v[88:89], v[90:91]
    v_pk_add_f32 v[82:83], v[92:93], v[94:95]
    v_pk_add_f32 v[84:85], v[16:17], v[18:19]
    v_pk_add_f32 v[86:87], v[20:21], v[22:23]
    v_pk_add_f32 v[80:81], v[80:81], v[96:97]
    v_pk_add_f32 v[82:83], v[82:83], v[98:99]
    v_pk_add_f32 v[84:85], v[84:85], v[24:25]
    v_pk_add_f32 v[86:87], v[86:87], v[26:27]
    v_pk_add_f32 v[80:81], v[80:81], v[100:101]
    v_pk_add_f32 v[82:83], v[82:83], v[102:103]
    v_pk_add_f32 v[84:85], v[84:85], v[28:29]
    v_pk_add_f32 v[86:87], v[86:87], v[30:31]
    v_pk_add_f32 v[80:81], v[80:81], v[82:83]
    v_pk_add_f32 v[84:85], v[84:85], v[86:87]
    v_add_f32 v80, v80, v81
    v_add_f32 v84, v84, v85
    v_rcp_f32 v80, v80
    v_rcp_f32 v84, v84
    v_pk_mul_f32 v[88:89], v[88:89], v[80:81] op_sel_hi:[1,0]
    v_pk_mul_f32 v[90:91], v[90:91], v[80:81] op_sel_hi:[1,0]
    v_pk_mul_f32 v[92:93], v[92:93], v[80:81] op_sel_hi:[1,0]
    v_pk_mul_f32 v[94:95], v[94:95], v[80:81] op_sel_hi:[1,0]
    v_cvt_pk_bf16_f32 v88, v88, v89
    v_cvt_pk_bf16_f32 v89, v90, v91
    v_cvt_pk_bf16_f32 v90, v92, v93
    v_cvt_pk_bf16_f32 v91, v94, v95
    v_pk_mul_f32 v[96:97], v[96:97], v[80:81] op_sel_hi:[1,0]
    v_pk_mul_f32 v[98:99], v[98:99], v[80:81] op_sel_hi:[1,0]
    v_pk_mul_f32 v[100:101], v[100:101], v[80:81] op_sel_hi:[1,0]
    v_pk_mul_f32 v[102:103], v[102:103], v[80:81] op_sel_hi:[1,0]
    v_cvt_pk_bf16_f32 v92, v96, v97
    v_cvt_pk_bf16_f32 v93, v98, v99
    v_cvt_pk_bf16_f32 v94, v100, v101
    v_cvt_pk_bf16_f32 v95, v102, v103
    v_pk_mul_f32 v[16:17], v[16:17], v[84:85] op_sel_hi:[1,0]
    v_pk_mul_f32 v[18:19], v[18:19], v[84:85] op_sel_hi:[1,0]
    v_pk_mul_f32 v[20:21], v[20:21], v[84:85] op_sel_hi:[1,0]
    v_pk_mul_f32 v[22:23], v[22:23], v[84:85] op_sel_hi:[1,0]
    v_cvt_pk_bf16_f32 v16, v16, v17
    v_cvt_pk_bf16_f32 v17, v18, v19
    v_cvt_pk_bf16_f32 v18, v20, v21
    v_cvt_pk_bf16_f32 v19, v22, v23
    v_pk_mul_f32 v[24:25], v[24:25], v[84:85] op_sel_hi:[1,0]
    v_pk_mul_f32 v[26:27], v[26:27], v[84:85] op_sel_hi:[1,0]
    v_pk_mul_f32 v[28:29], v[28:29], v[84:85] op_sel_hi:[1,0]
    v_pk_mul_f32 v[30:31], v[30:31], v[84:85] op_sel_hi:[1,0]
    v_cvt_pk_bf16_f32 v20, v24, v25
    v_cvt_pk_bf16_f32 v21, v26, v27
    v_cvt_pk_bf16_f32 v22, v28, v29
    v_cvt_pk_bf16_f32 v23, v30, v31
    v_permlane32_swap_b32 v88, v92
    v_permlane32_swap_b32 v89, v93
    v_permlane32_swap_b32 v90, v94
    v_permlane32_swap_b32 v91, v95
    v_permlane32_swap_b32 v16, v20
    v_permlane32_swap_b32 v17, v21
    v_permlane32_swap_b32 v18, v22
    v_permlane32_swap_b32 v19, v23
    v_max3_f32 v104, v32, v33, v34
    v_max3_f32 v105, v35, v36, v37
    v_min3_f32 v106, v32, v33, v34
    v_min3_f32 v107, v35, v36, v37
    v_max3_f32 v104, v104, v38, v39
    v_max3_f32 v105, v105, v40, v41
    v_min3_f32 v106, v106, v38, v39
    v_min3_f32 v107, v107, v40, v41
    v_max3_f32 v104, v104, v42, v43
    v_max3_f32 v105, v105, v44, v45
    v_min3_f32 v106, v106, v42, v43
    v_min3_f32 v107, v107, v44, v45
    v_max3_f32 v104, v104, v46, v47
    v_min3_f32 v106, v106, v46, v47
    v_max_f32 v104, v104, v105
    v_min_f32 v106, v106, v107
    v_mul_f32 v104, s52, v104
    v_mul_f32 v106, s52, v106
    v_pk_fma_f32 v[128:129], v[32:33], s[52:53], v[104:105] op_sel_hi:[1,1,0] neg_lo:[0,0,1] neg_hi:[0,0,1]
    v_pk_fma_f32 v[130:131], v[34:35], s[52:53], v[104:105] op_sel_hi:[1,1,0] neg_lo:[0,0,1] neg_hi:[0,0,1]
    v_pk_fma_f32 v[132:133], v[36:37], s[52:53], v[104:105] op_sel_hi:[1,1,0] neg_lo:[0,0,1] neg_hi:[0,0,1]
    v_pk_fma_f32 v[134:135], v[38:39], s[52:53], v[104:105] op_sel_hi:[1,1,0] neg_lo:[0,0,1] neg_hi:[0,0,1]
    v_pk_fma_f32 v[136:137], v[40:41], s[52:53], v[104:105] op_sel_hi:[1,1,0] neg_lo:[0,0,1] neg_hi:[0,0,1]
    v_pk_fma_f32 v[138:139], v[42:43], s[52:53], v[104:105] op_sel_hi:[1,1,0] neg_lo:[0,0,1] neg_hi:[0,0,1]
    v_pk_fma_f32 v[140:141], v[44:45], s[52:53], v[104:105] op_sel_hi:[1,1,0] neg_lo:[0,0,1] neg_hi:[0,0,1]
    v_pk_fma_f32 v[142:143], v[46:47], s[52:53], v[104:105] op_sel_hi:[1,1,0] neg_lo:[0,0,1] neg_hi:[0,0,1]
    v_pk_fma_f32 v[32:33], v[32:33], s[52:53], v[106:107] op_sel_hi:[1,1,0] neg_lo:[1,0,0] neg_hi:[1,0,0]
    v_pk_fma_f32 v[34:35], v[34:35], s[52:53], v[106:107] op_sel_hi:[1,1,0] neg_lo:[1,0,0] neg_hi:[1,0,0]
    v_pk_fma_f32 v[36:37], v[36:37], s[52:53], v[106:107] op_sel_hi:[1,1,0] neg_lo:[1,0,0] neg_hi:[1,0,0]
    v_pk_fma_f32 v[38:39], v[38:39], s[52:53], v[106:107] op_sel_hi:[1,1,0] neg_lo:[1,0,0] neg_hi:[1,0,0]
    v_pk_fma_f32 v[40:41], v[40:41], s[52:53], v[106:107] op_sel_hi:[1,1,0] neg_lo:[1,0,0] neg_hi:[1,0,0]
    v_pk_fma_f32 v[42:43], v[42:43], s[52:53], v[106:107] op_sel_hi:[1,1,0] neg_lo:[1,0,0] neg_hi:[1,0,0]
    v_pk_fma_f32 v[44:45], v[44:45], s[52:53], v[106:107] op_sel_hi:[1,1,0] neg_lo:[1,0,0] neg_hi:[1,0,0]
    v_pk_fma_f32 v[46:47], v[46:47], s[52:53], v[106:107] op_sel_hi:[1,1,0] neg_lo:[1,0,0] neg_hi:[1,0,0]
    v_exp_f32 v128, v128
    v_exp_f32 v129, v129
    v_exp_f32 v130, v130
    v_exp_f32 v131, v131
    v_exp_f32 v132, v132
    v_exp_f32 v133, v133
    v_exp_f32 v134, v134
    v_exp_f32 v135, v135
    v_exp_f32 v136, v136
    v_exp_f32 v137, v137
    v_exp_f32 v138, v138
    v_exp_f32 v139, v139
    v_exp_f32 v140, v140
    v_exp_f32 v141, v141
    v_exp_f32 v142, v142
    v_exp_f32 v143, v143
    v_exp_f32 v32, v32
    v_exp_f32 v33, v33
    v_exp_f32 v34, v34
    v_exp_f32 v35, v35
    v_exp_f32 v36, v36
    v_exp_f32 v37, v37
    v_exp_f32 v38, v38
    v_exp_f32 v39, v39
    v_exp_f32 v40, v40
    v_exp_f32 v41, v41
    v_exp_f32 v42, v42
    v_exp_f32 v43, v43
    v_exp_f32 v44, v44
    v_exp_f32 v45, v45
    v_exp_f32 v46, v46
    v_exp_f32 v47, v47
    v_pk_add_f32 v[80:81], v[128:129], v[130:131]
    v_pk_add_f32 v[82:83], v[132:133], v[134:135]
    v_pk_add_f32 v[84:85], v[32:33], v[34:35]
    v_pk_add_f32 v[86:87], v[36:37], v[38:39]
    v_pk_add_f32 v[80:81], v[80:81], v[136:137]
    v_pk_add_f32 v[82:83], v[82:83], v[138:139]
    v_pk_add_f32 v[84:85], v[84:85], v[40:41]
    v_pk_add_f32 v[86:87], v[86:87], v[42:43]
    v_pk_add_f32 v[80:81], v[80:81], v[140:141]
    v_pk_add_f32 v[82:83], v[82:83], v[142:143]
    v_pk_add_f32 v[84:85], v[84:85], v[44:45]
    v_pk_add_f32 v[86:87], v[86:87], v[46:47]
    v_pk_add_f32 v[80:81], v[80:81], v[82:83]
    v_pk_add_f32 v[84:85], v[84:85], v[86:87]
    v_add_f32 v80, v80, v81
    v_add_f32 v84, v84, v85
    v_rcp_f32 v80, v80
    v_rcp_f32 v84, v84
    v_pk_mul_f32 v[128:129], v[128:129], v[80:81] op_sel_hi:[1,0]
    v_pk_mul_f32 v[130:131], v[130:131], v[80:81] op_sel_hi:[1,0]
    v_pk_mul_f32 v[132:133], v[132:133], v[80:81] op_sel_hi:[1,0]
    v_pk_mul_f32 v[134:135], v[134:135], v[80:81] op_sel_hi:[1,0]
    v_cvt_pk_bf16_f32 v128, v128, v129
    v_cvt_pk_bf16_f32 v129, v130, v131
    v_cvt_pk_bf16_f32 v130, v132, v133
    v_cvt_pk_bf16_f32 v131, v134, v135
    v_pk_mul_f32 v[136:137], v[136:137], v[80:81] op_sel_hi:[1,0]
    v_pk_mul_f32 v[138:139], v[138:139], v[80:81] op_sel_hi:[1,0]
    v_pk_mul_f32 v[140:141], v[140:141], v[80:81] op_sel_hi:[1,0]
    v_pk_mul_f32 v[142:143], v[142:143], v[80:81] op_sel_hi:[1,0]
    v_cvt_pk_bf16_f32 v132, v136, v137
    v_cvt_pk_bf16_f32 v133, v138, v139
    v_cvt_pk_bf16_f32 v134, v140, v141
    v_cvt_pk_bf16_f32 v135, v142, v143
    v_pk_mul_f32 v[32:33], v[32:33], v[84:85] op_sel_hi:[1,0]
    v_pk_mul_f32 v[34:35], v[34:35], v[84:85] op_sel_hi:[1,0]
    v_pk_mul_f32 v[36:37], v[36:37], v[84:85] op_sel_hi:[1,0]
    v_pk_mul_f32 v[38:39], v[38:39], v[84:85] op_sel_hi:[1,0]
    v_cvt_pk_bf16_f32 v32, v32, v33
    v_cvt_pk_bf16_f32 v33, v34, v35
    v_cvt_pk_bf16_f32 v34, v36, v37
    v_cvt_pk_bf16_f32 v35, v38, v39
    v_pk_mul_f32 v[40:41], v[40:41], v[84:85] op_sel_hi:[1,0]
    v_pk_mul_f32 v[42:43], v[42:43], v[84:85] op_sel_hi:[1,0]
    v_pk_mul_f32 v[44:45], v[44:45], v[84:85] op_sel_hi:[1,0]
    v_pk_mul_f32 v[46:47], v[46:47], v[84:85] op_sel_hi:[1,0]
    v_cvt_pk_bf16_f32 v36, v40, v41
    v_cvt_pk_bf16_f32 v37, v42, v43
    v_cvt_pk_bf16_f32 v38, v44, v45
    v_cvt_pk_bf16_f32 v39, v46, v47
    ds_read_b32 v125, v126 offset:12
    v_permlane32_swap_b32 v128, v132
    v_permlane32_swap_b32 v129, v133
    v_permlane32_swap_b32 v130, v134
    v_permlane32_swap_b32 v131, v135
    v_permlane32_swap_b32 v32, v36
    v_permlane32_swap_b32 v33, v37
    v_permlane32_swap_b32 v34, v38
    v_permlane32_swap_b32 v35, v39
    s_waitcnt vmcnt(0)
    s_waitcnt lgkmcnt(0)
    v_readfirstlane_b32 s50, v125
    s_cmp_lt_u32 s50, 4
    s_cbranch_scc0 L_m_6
L_m_6_r:
    ds_read_b32 v125, v126 offset:12
    s_waitcnt lgkmcnt(0)
    v_readfirstlane_b32 s50, v125
    s_cmp_lt_u32 s50, 4
    s_cbranch_scc1 L_m_6_r
L_m_6:
    ds_read_b128 v[144:147], v122 offset:0
    ds_read_b128 v[148:151], v122 offset:576
    ds_read_b128 v[152:155], v122 offset:1152
    ds_read_b128 v[156:159], v122 offset:1728
    ds_read_b128 v[160:163], v122 offset:2304
    ds_read_b128 v[164:167], v122 offset:2880
    ds_read_b128 v[168:171], v122 offset:3456
    ds_read_b128 v[172:175], v122 offset:4032
    s_mov_b32 exec_hi, 0
L_TA1_0:
    s_cbranch_execz L_TretA
    s_nop 0
    buffer_store_dword v14, v15, s[16:19], s57 offen sc1
    s_mov_b64 exec, -1
    s_waitcnt lgkmcnt(7)
    v_mfma_f32_32x32x16_bf16 v[176:191], v[144:147], v[88:91], 0
    s_waitcnt lgkmcnt(6)
    v_mfma_f32_32x32x16_bf16 v[176:191], v[148:151], v[16:19], v[176:191]
    s_waitcnt lgkmcnt(5)
    v_mfma_f32_32x32x16_bf16 v[192:207], v[152:155], v[92:95], 0
    s_waitcnt lgkmcnt(4)
    v_mfma_f32_32x32x16_bf16 v[192:207], v[156:159], v[20:23], v[192:207]
    s_waitcnt lgkmcnt(3)
    v_mfma_f32_32x32x16_bf16 v[208:223], v[160:163], v[128:131], 0
    s_nop 5
    v_add_f32 v184, 0x358637bd, v184
    v_rcp_f32 v184, v184
    s_nop 0
    v_mul_f32 v176, v176, v184
    v_mul_f32 v177, v177, v184
    v_mul_f32 v178, v178, v184
    v_mul_f32 v179, v179, v184
    v_mul_f32 v180, v180, v184
    v_mul_f32 v181, v181, v184
    v_mul_f32 v182, v182, v184
    v_mul_f32 v183, v183, v184
    s_waitcnt lgkmcnt(2)
    v_mfma_f32_32x32x16_bf16 v[208:223], v[164:167], v[32:35], v[208:223]
    v_cvt_pk_bf16_f32 v188, v176, v177
    v_cvt_pk_bf16_f32 v189, v178, v179
    v_cvt_pk_bf16_f32 v190, v180, v181
    v_cvt_pk_bf16_f32 v191, v182, v183
    buffer_store_dwordx4 v[188:191], v13, s[16:19], s56 offen offset:0 sc1
    s_waitcnt lgkmcnt(1)
    v_mfma_f32_32x32x16_bf16 v[224:239], v[168:171], v[132:135], 0
    v_add_f32 v200, 0x358637bd, v200
    v_rcp_f32 v200, v200
    s_nop 0
    v_mul_f32 v192, v192, v200
    v_mul_f32 v193, v193, v200
    v_mul_f32 v194, v194, v200
    v_mul_f32 v195, v195, v200
    v_mul_f32 v196, v196, v200
    v_mul_f32 v197, v197, v200
    v_mul_f32 v198, v198, v200
    v_mul_f32 v199, v199, v200
    s_waitcnt lgkmcnt(0)
    v_mfma_f32_32x32x16_bf16 v[224:239], v[172:175], v[36:39], v[224:239]
    v_cvt_pk_bf16_f32 v204, v192, v193
    v_cvt_pk_bf16_f32 v205, v194, v195
    v_cvt_pk_bf16_f32 v206, v196, v197
    v_cvt_pk_bf16_f32 v207, v198, v199
    buffer_store_dwordx4 v[204:207], v13, s[16:19], s56 offen offset:1024 sc1
    v_add_f32 v216, 0x358637bd, v216
    v_rcp_f32 v216, v216
    s_nop 0
    v_pk_mul_f32 v[208:209], v[208:209], v[216:217] op_sel_hi:[1,0]
    v_pk_mul_f32 v[210:211], v[210:211], v[216:217] op_sel_hi:[1,0]
    v_pk_mul_f32 v[212:213], v[212:213], v[216:217] op_sel_hi:[1,0]
    v_pk_mul_f32 v[214:215], v[214:215], v[216:217] op_sel_hi:[1,0]
    v_cvt_pk_bf16_f32 v220, v208, v209
    v_cvt_pk_bf16_f32 v221, v210, v211
    v_cvt_pk_bf16_f32 v222, v212, v213
    v_cvt_pk_bf16_f32 v223, v214, v215
    buffer_store_dwordx4 v[220:223], v13, s[16:19], s56 offen offset:2048 sc1
    v_add_f32 v232, 0x358637bd, v232
    v_rcp_f32 v232, v232
    s_nop 0
    v_pk_mul_f32 v[224:225], v[224:225], v[232:233] op_sel_hi:[1,0]
    v_pk_mul_f32 v[226:227], v[226:227], v[232:233] op_sel_hi:[1,0]
    v_pk_mul_f32 v[228:229], v[228:229], v[232:233] op_sel_hi:[1,0]
    v_pk_mul_f32 v[230:231], v[230:231], v[232:233] op_sel_hi:[1,0]
    v_cvt_pk_bf16_f32 v236, v224, v225
    v_cvt_pk_bf16_f32 v237, v226, v227
    v_cvt_pk_bf16_f32 v238, v228, v229
    v_cvt_pk_bf16_f32 v239, v230, v231
    buffer_store_dwordx4 v[236:239], v13, s[16:19], s56 offen offset:3072 sc1
    s_branch L_P2A2
L_AK:
    v_lshlrev_b32 v18, 4, v16
    v_xor_b32_e64 v20, v20, v18
    v_lshl_add_u32 v20, v16, 13, v20
    v_add_u32 v112, 0x10000, v20
    v_xor_b32 v113, 16, v112
    v_xor_b32 v114, 32, v112
    v_xor_b32 v115, 48, v112
    v_and_b32 v17, 15, v0
    v_lshrrev_b32 v18, 4, v0
    v_lshlrev_b32 v121, 4, v17
    v_lshl_add_u32 v116, v18, 3, v121
    v_lshl_add_u32 v121, v18, 10, v121
    s_mul_i32 s50, s84, 1152
    s_add_u32 s50, s50, 0x26c00
    v_add_u32_e64 v116, s50, v116
    v_bfe_u32 v117, v0, 1, 1
    v_mul_u32_u24 v117, 576, v117
    v_and_b32_e64 v19, 1, v0
    v_lshl_add_u32 v117, v19, 4, v117
    v_lshl_add_u32 v117, v18, 3, v117
    s_add_u32 s50, s50, 512
    v_add_u32 v117, s50, v117
    v_lshlrev_b32 v19, 4, v19
    v_mov_b32 v18, 0x3f80
    v_lshlrev_b32 v18, v19, v18
    v_lshrrev_b32 v17, 1, v17
    v_cmp_eq_u32 vcc, 0, v17
    s_nop 1
    v_cndmask_b32 v56, 0, v18, vcc
    v_cmp_eq_u32 vcc, 1, v17
    s_nop 1
    v_cndmask_b32 v57, 0, v18, vcc
    v_cmp_eq_u32 vcc, 2, v17
    s_nop 1
    v_cndmask_b32 v58, 0, v18, vcc
    v_cmp_eq_u32 vcc, 3, v17
    s_nop 1
    v_cndmask_b32 v59, 0, v18, vcc
    v_and_b32 v123, 15, v0
    v_lshlrev_b32 v123, 7, v123
    v_subrev_u32 v11, 0x18000, v3
    s_lshl_b32 s50, s42, 2
    s_add_u32 s50, s50, s84
    s_lshl_b32 s4, s50, 11
    s_add_u32 s4, s4, 0x540000
    s_lshl_b32 s5, s50, 14
    s_add_u32 s5, s5, 0x400000
    s_lshl_b32 s43, s50, 11
    s_add_u32 s43, s43, 0x500000
    s_lshl_b32 s50, s50, 4
    s_add_u32 s50, s50, s41
    s_lshl_b32 s3, s50, 7
    s_add_u32 s3, s3, 0x540000
    s_lshl_b32 s54, s50, 10
    s_add_u32 s54, s54, 0x400000
    s_lshl_b32 s55, s50, 7
    s_add_u32 s55, s55, 0x500000
    v_lshrrev_b32_e64 v118, 2, v0
    v_bfe_u32 v17, v0, 3, 2
    v_bfe_u32 v18, v0, 1, 1
    v_xor_b32 v17, v17, v18
    v_lshlrev_b32 v118, 6, v118
    v_lshl_add_u32 v118, v17, 4, v118
    v_and_b32 v17, 1, v0
    v_lshl_add_u32 v118, v17, 3, v118
    s_and_b32 s50, s84, 1
    s_lshl_b32 s50, s50, 5
    v_xor_b32 v119, s50, v118
    s_lshr_b32 s50, s84, 1
    s_lshl_b32 s50, s50, 13
    s_add_u32 s50, s50, 0x1c000
    v_add_u32 v119, s50, v119
    s_lshl_b32 s50, s84, 13
    s_add_u32 s50, s50, 0x10000
    v_add_u32 v118, s50, v118
    v_xor_b32 v122, 32, v118
    v_mov_b32 v60, 0x3f803f80
    v_mov_b32 v61, 0x3f803f80
    v_mov_b32 v62, 0x3f803f80
    v_mov_b32 v63, 0x3f803f80
    v_and_b32_e64 v120, 3, v0
    v_bfe_u32 v17, v0, 2, 1
    v_lshl_add_u32 v120, v17, 3, v120
    v_bfe_u32 v17, v0, 3, 1
    v_lshl_add_u32 v120, v17, 2, v120
    v_bfe_u32 v17, v0, 4, 1
    v_lshl_add_u32 v17, v17, 1, v16
    v_lshl_add_u32 v120, v17, 4, v120
    v_lshlrev_b32 v120, 4, v120
    v_lshlrev_b32 v108, 4, v17
    v_mov_b32 v200, -1
    v_mov_b32 v201, -1
    v_mov_b32 v202, -1
    v_mov_b32 v203, -1
    v_and_b32 v111, 0x3c0, v13
    v_add_u32 v111, v111, v13
    v_and_b32 v17, 15, v0
    v_xor_b32 v18, 1, v17
    v_cmp_eq_u32 vcc, s41, v17
    s_nop 1
    v_cndmask_b32 v17, v17, v18, vcc
    v_lshlrev_b32 v123, 7, v17
    s_lshl_b32 s50, s41, 2
    s_add_u32 s50, s50, s84
    s_lshl_b32 s57, s50, 5
    s_lshl_b32 s51, s42, 1
    s_add_u32 s57, s57, s51
    s_lshl_b32 s56, s57, 11
    s_lshl_b32 s57, s57, 7
    s_add_u32 s57, s57, 0x560000
    v_mov_b32 v204, s55
    v_mov_b32 v17, s3
    v_mov_b32 v18, s57
    v_cmp_lt_u32 vcc, 7, v0
    s_nop 1
    v_cndmask_b32 v204, v204, v17, vcc
    v_cmp_lt_u32 vcc, 15, v0
    s_nop 1
    v_cndmask_b32 v204, v204, v18, vcc
    v_and_b32 v17, 0x70, v13
    v_add_u32_e64 v204, v204, v17
    s_setprio 1
    s_add_u32 m0, s48, 0xa000
    s_add_u32 s49, s73, 0x400
    buffer_load_dwordx4 v3, s[12:15], s49 offen lds
    s_add_u32 m0, s48, 0xc000
    s_nop 0
    buffer_load_dwordx4 v1, s[8:11], s66 offen lds
    s_add_u32 m0, s48, 0xe000
    s_nop 0
    buffer_load_dwordx4 v2, s[8:11], s66 offen lds
    s_add_u32 m0, s48, 0x10000
    s_add_u32 s49, s74, 0x400
    buffer_load_dwordx4 v3, s[12:15], s49 offen lds
    s_waitcnt vmcnt(6) lgkmcnt(0)
    s_barrier
    ds_read_b128 v[128:131], v5 offset:0
    ds_read_b64_tr_b16 v[132:133], v9 offset:16384
    ds_read_b64_tr_b16 v[134:135], v9 offset:16896
    ds_read_b64_tr_b16 v[136:137], v10 offset:16384
    ds_read_b64_tr_b16 v[138:139], v10 offset:16896
    ds_read_b128 v[140:143], v6 offset:0
    ds_read_b64_tr_b16 v[144:145], v9 offset:18432
    ds_read_b64_tr_b16 v[146:147], v9 offset:18944
    ds_read_b64_tr_b16 v[148:149], v10 offset:18432
    ds_read_b64_tr_b16 v[150:151], v10 offset:18944
    ds_read_b128 v[152:155], v7 offset:0
    ds_read_b64_tr_b16 v[156:157], v9 offset:20480
    ds_read_b64_tr_b16 v[158:159], v9 offset:20992
    ds_read_b64_tr_b16 v[160:161], v10 offset:20480
    ds_read_b64_tr_b16 v[162:163], v10 offset:20992
    ds_read_b128 v[164:167], v8 offset:0
    ds_read_b64_tr_b16 v[168:169], v9 offset:22528
    ds_read_b64_tr_b16 v[170:171], v9 offset:23040
    ds_read_b64_tr_b16 v[172:173], v10 offset:22528
    ds_read_b64_tr_b16 v[174:175], v10 offset:23040
    s_waitcnt lgkmcnt(15)
    v_mfma_f32_32x32x16_bf16 v[16:31], v[132:135], v[128:131], 0
    v_mfma_f32_32x32x16_bf16 v[32:47], v[136:139], v[128:131], 0
    s_add_u32 m0, s48, 0x16000
    s_add_u32 s49, s75, 0x400
    buffer_load_dwordx4 v3, s[12:15], s49 offen lds
    s_waitcnt lgkmcnt(10)
    v_mfma_f32_32x32x16_bf16 v[16:31], v[144:147], v[140:143], v[16:31]
    v_mfma_f32_32x32x16_bf16 v[32:47], v[148:151], v[140:143], v[32:47]
    s_waitcnt vmcnt(4) lgkmcnt(0)
    s_barrier
    v_mfma_f32_32x32x16_bf16 v[16:31], v[156:159], v[152:155], v[16:31]
    ds_read_b128 v[176:179], v5 offset:24576
    ds_read_b64_tr_b16 v[180:181], v9 offset:40960
    ds_read_b64_tr_b16 v[182:183], v9 offset:41472
    ds_read_b64_tr_b16 v[184:185], v10 offset:40960
    ds_read_b64_tr_b16 v[186:187], v10 offset:41472
    v_mfma_f32_32x32x16_bf16 v[32:47], v[160:163], v[152:155], v[32:47]
    ds_read_b128 v[188:191], v6 offset:24576
    ds_read_b64_tr_b16 v[192:193], v9 offset:43008
    ds_read_b64_tr_b16 v[194:195], v9 offset:43520
    ds_read_b64_tr_b16 v[196:197], v10 offset:43008
    ds_read_b64_tr_b16 v[198:199], v10 offset:43520
    v_mfma_f32_32x32x16_bf16 v[16:31], v[168:171], v[164:167], v[16:31]
    ds_read_b128 v[128:131], v7 offset:24576
    ds_read_b64_tr_b16 v[132:133], v9 offset:45056
    ds_read_b64_tr_b16 v[134:135], v9 offset:45568
    ds_read_b64_tr_b16 v[136:137], v10 offset:45056
    ds_read_b64_tr_b16 v[138:139], v10 offset:45568
    v_mfma_f32_32x32x16_bf16 v[32:47], v[172:175], v[164:167], v[32:47]
    ds_read_b128 v[140:143], v8 offset:24576
    ds_read_b64_tr_b16 v[144:145], v9 offset:47104
    ds_read_b64_tr_b16 v[146:147], v9 offset:47616
    ds_read_b64_tr_b16 v[148:149], v10 offset:47104
    ds_read_b64_tr_b16 v[150:151], v10 offset:47616
    s_waitcnt lgkmcnt(15)
    v_mfma_f32_32x32x16_bf16 v[16:31], v[180:183], v[176:179], v[16:31]
    v_mfma_f32_32x32x16_bf16 v[32:47], v[184:187], v[176:179], v[32:47]
    s_add_u32 m0, s48, 0x4000
    s_add_u32 s49, s76, 0x400
    buffer_load_dwordx4 v3, s[12:15], s49 offen lds
    s_waitcnt lgkmcnt(10)
    v_mfma_f32_32x32x16_bf16 v[16:31], v[192:195], v[188:191], v[16:31]
    v_mfma_f32_32x32x16_bf16 v[32:47], v[196:199], v[188:191], v[32:47]
    s_waitcnt vmcnt(2) lgkmcnt(0)
    s_barrier
    v_mfma_f32_32x32x16_bf16 v[16:31], v[132:135], v[128:131], v[16:31]
    v_add_u32 v9, 0xc000, v9
    v_add_u32 v10, 0xc000, v10
    ds_read_b128 v[152:155], v5 offset:49152
    ds_read_b64_tr_b16 v[156:157], v9 offset:16384
    ds_read_b64_tr_b16 v[158:159], v9 offset:16896
    ds_read_b64_tr_b16 v[160:161], v10 offset:16384
    ds_read_b64_tr_b16 v[162:163], v10 offset:16896
    v_mfma_f32_32x32x16_bf16 v[32:47], v[136:139], v[128:131], v[32:47]
    ds_read_b128 v[164:167], v6 offset:49152
    ds_read_b64_tr_b16 v[168:169], v9 offset:18432
    ds_read_b64_tr_b16 v[170:171], v9 offset:18944
    ds_read_b64_tr_b16 v[172:173], v10 offset:18432
    ds_read_b64_tr_b16 v[174:175], v10 offset:18944
    v_mfma_f32_32x32x16_bf16 v[16:31], v[144:147], v[140:143], v[16:31]
    ds_read_b128 v[176:179], v7 offset:49152
    ds_read_b64_tr_b16 v[180:181], v9 offset:20480
    ds_read_b64_tr_b16 v[182:183], v9 offset:20992
    ds_read_b64_tr_b16 v[184:185], v10 offset:20480
    ds_read_b64_tr_b16 v[186:187], v10 offset:20992
    v_mfma_f32_32x32x16_bf16 v[32:47], v[148:151], v[140:143], v[32:47]
    ds_read_b128 v[188:191], v8 offset:49152
    ds_read_b64_tr_b16 v[192:193], v9 offset:22528
    ds_read_b64_tr_b16 v[194:195], v9 offset:23040
    ds_read_b64_tr_b16 v[196:197], v10 offset:22528
    ds_read_b64_tr_b16 v[198:199], v10 offset:23040
    s_waitcnt lgkmcnt(15)
    v_mfma_f32_32x32x16_bf16 v[16:31], v[156:159], v[152:155], v[16:31]
    v_mfma_f32_32x32x16_bf16 v[32:47], v[160:163], v[152:155], v[32:47]
    s_add_u32 m0, s48, 0xa000
    s_add_u32 s49, s77, 0x400
    buffer_load_dwordx4 v3, s[12:15], s49 offen lds
    s_waitcnt lgkmcnt(10)
    v_mfma_f32_32x32x16_bf16 v[16:31], v[168:171], v[164:167], v[16:31]
    v_mfma_f32_32x32x16_bf16 v[32:47], v[172:175], v[164:167], v[32:47]
    ds_read_b64_tr_b16 v[72:73], v12 offset:0
    ds_read_b64_tr_b16 v[74:75], v12 offset:256
    ds_read_b64_tr_b16 v[64:65], v12 offset:1024
    ds_read_b64_tr_b16 v[66:67], v12 offset:1280
    s_waitcnt vmcnt(2) lgkmcnt(0)
    s_barrier
    v_mfma_f32_32x32x16_bf16 v[16:31], v[180:183], v[176:179], v[16:31]
    v_add_u32 v5, 0xc000, v5
    v_add_u32 v6, 0xc000, v6
    v_add_u32 v7, 0xc000, v7
    v_add_u32 v8, 0xc000, v8
    ds_read_b128 v[128:131], v5 offset:24576
    ds_read_b64_tr_b16 v[132:133], v9 offset:40960
    ds_read_b64_tr_b16 v[134:135], v9 offset:41472
    ds_read_b64_tr_b16 v[136:137], v10 offset:40960
    ds_read_b64_tr_b16 v[138:139], v10 offset:41472
    v_mfma_f32_32x32x16_bf16 v[32:47], v[184:187], v[176:179], v[32:47]
    ds_read_b128 v[140:143], v6 offset:24576
    ds_read_b64_tr_b16 v[144:145], v9 offset:43008
    ds_read_b64_tr_b16 v[146:147], v9 offset:43520
    ds_read_b64_tr_b16 v[148:149], v10 offset:43008
    ds_read_b64_tr_b16 v[150:151], v10 offset:43520
    v_mfma_f32_32x32x16_bf16 v[16:31], v[192:195], v[188:191], v[16:31]
    ds_read_b128 v[152:155], v7 offset:24576
    ds_read_b64_tr_b16 v[156:157], v9 offset:45056
    ds_read_b64_tr_b16 v[158:159], v9 offset:45568
    ds_read_b64_tr_b16 v[160:161], v10 offset:45056
    ds_read_b64_tr_b16 v[162:163], v10 offset:45568
    v_mfma_f32_32x32x16_bf16 v[32:47], v[196:199], v[188:191], v[32:47]
    ds_read_b128 v[164:167], v8 offset:24576
    ds_read_b64_tr_b16 v[168:169], v9 offset:47104
    ds_read_b64_tr_b16 v[170:171], v9 offset:47616
    ds_read_b64_tr_b16 v[172:173], v10 offset:47104
    ds_read_b64_tr_b16 v[174:175], v10 offset:47616
    s_waitcnt lgkmcnt(15)
    v_mfma_f32_32x32x16_bf16 v[16:31], v[132:135], v[128:131], v[16:31]
    v_mfma_f32_32x32x16_bf16 v[32:47], v[136:139], v[128:131], v[32:47]
    s_add_u32 m0, s48, 0x10000
    s_add_u32 s49, s78, 0x400
    buffer_load_dwordx4 v3, s[12:15], s49 offen lds
    s_waitcnt lgkmcnt(10)
    v_mfma_f32_32x32x16_bf16 v[16:31], v[144:147], v[140:143], v[16:31]
    v_mfma_f32_32x32x16_bf16 v[32:47], v[148:151], v[140:143], v[32:47]
    s_add_u32 m0, s48, 0x18000
    s_add_u32 s49, s72, 0x800
    buffer_load_dwordx4 v3, s[12:15], s49 offen lds
    v_and_b32 v125, 4, v0
    v_cmp_eq_u32_e64 vcc, 0, v125
    s_nop 1
    v_cndmask_b32 v76, v72, 0, vcc
    v_cndmask_b32 v77, v73, 0, vcc
    v_cndmask_b32 v78, v74, 0, vcc
    v_cndmask_b32 v79, v75, 0, vcc
    v_cndmask_b32 v72, 0, v72, vcc
    v_cndmask_b32 v73, 0, v73, vcc
    v_cndmask_b32 v74, 0, v74, vcc
    v_cndmask_b32 v75, 0, v75, vcc
    s_waitcnt vmcnt(3) lgkmcnt(0)
    s_barrier
    v_mfma_f32_32x32x16_bf16 v[16:31], v[156:159], v[152:155], v[16:31]
    v_add_u32 v5, 0xffff4000, v5
    v_add_u32 v6, 0xffff4000, v6
    v_add_u32 v7, 0xffff4000, v7
    v_add_u32 v8, 0xffff4000, v8
    v_add_u32 v9, 0xffff4000, v9
    v_add_u32 v10, 0xffff4000, v10
    ds_read_b128 v[176:179], v5 offset:0
    ds_read_b64_tr_b16 v[180:181], v9 offset:16384
    ds_read_b64_tr_b16 v[182:183], v9 offset:16896
    ds_read_b64_tr_b16 v[184:185], v10 offset:16384
    ds_read_b64_tr_b16 v[186:187], v10 offset:16896
    v_mfma_f32_32x32x16_bf16 v[32:47], v[160:163], v[152:155], v[32:47]
    ds_read_b128 v[188:191], v6 offset:0
    ds_read_b64_tr_b16 v[192:193], v9 offset:18432
    ds_read_b64_tr_b16 v[194:195], v9 offset:18944
    ds_read_b64_tr_b16 v[196:197], v10 offset:18432
    ds_read_b64_tr_b16 v[198:199], v10 offset:18944
    v_mfma_f32_32x32x16_bf16 v[16:31], v[168:171], v[164:167], v[16:31]
    ds_read_b128 v[128:131], v7 offset:0
    ds_read_b64_tr_b16 v[132:133], v9 offset:20480
    ds_read_b64_tr_b16 v[134:135], v9 offset:20992
    ds_read_b64_tr_b16 v[136:137], v10 offset:20480
    ds_read_b64_tr_b16 v[138:139], v10 offset:20992
    v_mfma_f32_32x32x16_bf16 v[32:47], v[172:175], v[164:167], v[32:47]
    ds_read_b128 v[140:143], v8 offset:0
    ds_read_b64_tr_b16 v[144:145], v9 offset:22528
    ds_read_b64_tr_b16 v[146:147], v9 offset:23040
    ds_read_b64_tr_b16 v[148:149], v10 offset:22528
    ds_read_b64_tr_b16 v[150:151], v10 offset:23040
    s_waitcnt lgkmcnt(15)
    v_mfma_f32_32x32x16_bf16 v[16:31], v[180:183], v[176:179], v[16:31]
    v_mfma_f32_32x32x16_bf16 v[32:47], v[184:187], v[176:179], v[32:47]
    s_add_u32 m0, s48, 0x16000
    s_add_u32 s49, s79, 0x400
    buffer_load_dwordx4 v3, s[12:15], s49 offen lds
    s_waitcnt lgkmcnt(10)
    v_mfma_f32_32x32x16_bf16 v[16:31], v[192:195], v[188:191], v[16:31]
    v_mfma_f32_32x32x16_bf16 v[32:47], v[196:199], v[188:191], v[32:47]
    s_add_u32 m0, s48, 0x17000
    s_add_u32 s49, s72, 0x800
    buffer_load_dwordx4 v11, s[12:15], s49 offen lds
    v_and_b32 v125, 4, v0
    v_cmp_eq_u32_e64 vcc, 0, v125
    s_nop 1
    v_cndmask_b32 v68, v64, 0, vcc
    v_cndmask_b32 v69, v65, 0, vcc
    v_cndmask_b32 v70, v66, 0, vcc
    v_cndmask_b32 v71, v67, 0, vcc
    v_cndmask_b32 v64, 0, v64, vcc
    v_cndmask_b32 v65, 0, v65, vcc
    v_cndmask_b32 v66, 0, v66, vcc
    v_cndmask_b32 v67, 0, v67, vcc
    s_waitcnt vmcnt(4) lgkmcnt(0)
    s_barrier
    v_mfma_f32_32x32x16_bf16 v[16:31], v[132:135], v[128:131], v[16:31]
    ds_read_b128 v[152:155], v5 offset:24576
    ds_read_b64_tr_b16 v[156:157], v9 offset:40960
    ds_read_b64_tr_b16 v[158:159], v9 offset:41472
    ds_read_b64_tr_b16 v[160:161], v10 offset:40960
    ds_read_b64_tr_b16 v[162:163], v10 offset:41472
    v_mfma_f32_32x32x16_bf16 v[32:47], v[136:139], v[128:131], v[32:47]
    ds_read_b128 v[164:167], v6 offset:24576
    ds_read_b64_tr_b16 v[168:169], v9 offset:43008
    ds_read_b64_tr_b16 v[170:171], v9 offset:43520
    ds_read_b64_tr_b16 v[172:173], v10 offset:43008
    ds_read_b64_tr_b16 v[174:175], v10 offset:43520
    v_mfma_f32_32x32x16_bf16 v[16:31], v[144:147], v[140:143], v[16:31]
    ds_read_b128 v[176:179], v7 offset:24576
    ds_read_b64_tr_b16 v[180:181], v9 offset:45056
    ds_read_b64_tr_b16 v[182:183], v9 offset:45568
    ds_read_b64_tr_b16 v[184:185], v10 offset:45056
    ds_read_b64_tr_b16 v[186:187], v10 offset:45568
    v_mfma_f32_32x32x16_bf16 v[32:47], v[148:151], v[140:143], v[32:47]
    ds_read_b128 v[188:191], v8 offset:24576
    ds_read_b64_tr_b16 v[192:193], v9 offset:47104
    ds_read_b64_tr_b16 v[194:195], v9 offset:47616
    ds_read_b64_tr_b16 v[196:197], v10 offset:47104
    ds_read_b64_tr_b16 v[198:199], v10 offset:47616
    s_waitcnt lgkmcnt(15)
    v_mfma_f32_32x32x16_bf16 v[16:31], v[156:159], v[152:155], v[16:31]
    v_mfma_f32_32x32x16_bf16 v[32:47], v[160:163], v[152:155], v[32:47]
    s_add_u32 m0, s48, 0x24000
    s_add_u32 s49, s75, 0x800
    buffer_load_dwordx4 v3, s[12:15], s49 offen lds
    s_waitcnt lgkmcnt(10)
    v_mfma_f32_32x32x16_bf16 v[16:31], v[168:171], v[164:167], v[16:31]
    v_mfma_f32_32x32x16_bf16 v[32:47], v[172:175], v[164:167], v[32:47]
    s_waitcnt vmcnt(4) lgkmcnt(0)
    s_barrier
    v_mfma_f32_32x32x16_bf16 v[16:31], v[180:183], v[176:179], v[16:31]
    v_add_u32 v9, 0xc000, v9
    v_add_u32 v10, 0xc000, v10
    ds_read_b128 v[128:131], v5 offset:49152
    ds_read_b64_tr_b16 v[132:133], v9 offset:16384
    ds_read_b64_tr_b16 v[134:135], v9 offset:16896
    ds_read_b64_tr_b16 v[136:137], v10 offset:16384
    ds_read_b64_tr_b16 v[138:139], v10 offset:16896
    v_mfma_f32_32x32x16_bf16 v[32:47], v[184:187], v[176:179], v[32:47]
    ds_read_b128 v[140:143], v6 offset:49152
    ds_read_b64_tr_b16 v[144:145], v9 offset:18432
    ds_read_b64_tr_b16 v[146:147], v9 offset:18944
    ds_read_b64_tr_b16 v[148:149], v10 offset:18432
    ds_read_b64_tr_b16 v[150:151], v10 offset:18944
    v_mfma_f32_32x32x16_bf16 v[16:31], v[192:195], v[188:191], v[16:31]
    ds_read_b128 v[152:155], v7 offset:49152
    ds_read_b64_tr_b16 v[156:157], v9 offset:20480
    ds_read_b64_tr_b16 v[158:159], v9 offset:20992
    ds_read_b64_tr_b16 v[160:161], v10 offset:20480
    ds_read_b64_tr_b16 v[162:163], v10 offset:20992
    v_mfma_f32_32x32x16_bf16 v[32:47], v[196:199], v[188:191], v[32:47]
    ds_read_b128 v[164:167], v8 offset:49152
    ds_read_b64_tr_b16 v[168:169], v9 offset:22528
    ds_read_b64_tr_b16 v[170:171], v9 offset:23040
    ds_read_b64_tr_b16 v[172:173], v10 offset:22528
    ds_read_b64_tr_b16 v[174:175], v10 offset:23040
    s_waitcnt lgkmcnt(15)
    v_mfma_f32_32x32x16_bf16 v[16:31], v[132:135], v[128:131], v[16:31]
    v_mfma_f32_32x32x16_bf16 v[32:47], v[136:139], v[128:131], v[32:47]
    s_add_u32 m0, s48, 0x4000
    s_add_u32 s49, s78, 0x800
    buffer_load_dwordx4 v3, s[12:15], s49 offen lds
    s_waitcnt lgkmcnt(10)
    v_mfma_f32_32x32x16_bf16 v[16:31], v[144:147], v[140:143], v[16:31]
    v_mfma_f32_32x32x16_bf16 v[32:47], v[148:151], v[140:143], v[32:47]
    s_waitcnt vmcnt(2) lgkmcnt(0)
    s_barrier
    v_mfma_f32_32x32x16_bf16 v[16:31], v[156:159], v[152:155], v[16:31]
    v_add_u32 v5, 0xc000, v5
    v_add_u32 v6, 0xc000, v6
    v_add_u32 v7, 0xc000, v7
    v_add_u32 v8, 0xc000, v8
    ds_read_b128 v[176:179], v5 offset:24576
    ds_read_b64_tr_b16 v[180:181], v9 offset:40960
    ds_read_b64_tr_b16 v[182:183], v9 offset:41472
    ds_read_b64_tr_b16 v[184:185], v10 offset:40960
    ds_read_b64_tr_b16 v[186:187], v10 offset:41472
    v_mfma_f32_32x32x16_bf16 v[32:47], v[160:163], v[152:155], v[32:47]
    ds_read_b128 v[188:191], v6 offset:24576
    ds_read_b64_tr_b16 v[192:193], v9 offset:43008
    ds_read_b64_tr_b16 v[194:195], v9 offset:43520
    ds_read_b64_tr_b16 v[196:197], v10 offset:43008
    ds_read_b64_tr_b16 v[198:199], v10 offset:43520
    v_mfma_f32_32x32x16_bf16 v[16:31], v[168:171], v[164:167], v[16:31]
    ds_read_b128 v[128:131], v7 offset:24576
    ds_read_b64_tr_b16 v[132:133], v9 offset:45056
    ds_read_b64_tr_b16 v[134:135], v9 offset:45568
    ds_read_b64_tr_b16 v[136:137], v10 offset:45056
    ds_read_b64_tr_b16 v[138:139], v10 offset:45568
    v_mfma_f32_32x32x16_bf16 v[32:47], v[172:175], v[164:167], v[32:47]
    ds_read_b128 v[140:143], v8 offset:24576
    ds_read_b64_tr_b16 v[144:145], v9 offset:47104
    ds_read_b64_tr_b16 v[146:147], v9 offset:47616
    ds_read_b64_tr_b16 v[148:149], v10 offset:47104
    ds_read_b64_tr_b16 v[150:151], v10 offset:47616
    s_waitcnt lgkmcnt(15)
    v_mfma_f32_32x32x16_bf16 v[16:31], v[180:183], v[176:179], v[16:31]
    v_mfma_f32_32x32x16_bf16 v[32:47], v[184:187], v[176:179], v[32:47]
    s_waitcnt lgkmcnt(10)
    v_mfma_f32_32x32x16_bf16 v[16:31], v[192:195], v[188:191], v[16:31]
    v_mfma_f32_32x32x16_bf16 v[32:47], v[196:199], v[188:191], v[32:47]
    s_waitcnt lgkmcnt(5)
    v_mfma_f32_32x32x16_bf16 v[16:31], v[132:135], v[128:131], v[16:31]
    v_mfma_f32_32x32x16_bf16 v[32:47], v[136:139], v[128:131], v[32:47]
    s_waitcnt lgkmcnt(0)
    v_mfma_f32_32x32x16_bf16 v[16:31], v[144:147], v[140:143], v[16:31]
    v_mfma_f32_32x32x16_bf16 v[32:47], v[148:151], v[140:143], v[32:47]
    s_nop 10
    v_cvt_pk_bf16_f32 v80, v16, v17
    v_cvt_pk_bf16_f32 v81, v18, v19
    v_cvt_pk_bf16_f32 v82, v20, v21
    v_cvt_pk_bf16_f32 v83, v22, v23
    v_cvt_pk_bf16_f32 v84, v24, v25
    v_cvt_pk_bf16_f32 v85, v26, v27
    v_cvt_pk_bf16_f32 v86, v28, v29
    v_cvt_pk_bf16_f32 v87, v30, v31
    v_mfma_f32_32x32x16_bf16 v[16:31], v[72:75], v[80:83], 0
    s_nop 0
    v_mfma_f32_32x32x16_bf16 v[16:31], v[76:79], v[84:87], v[16:31]
    v_cvt_pk_bf16_f32 v48, v32, v33
    v_cvt_pk_bf16_f32 v49, v34, v35
    v_cvt_pk_bf16_f32 v50, v36, v37
    v_cvt_pk_bf16_f32 v51, v38, v39
    v_cvt_pk_bf16_f32 v52, v40, v41
    v_cvt_pk_bf16_f32 v53, v42, v43
    v_cvt_pk_bf16_f32 v54, v44, v45
    v_cvt_pk_bf16_f32 v55, v46, v47
    v_mfma_f32_32x32x16_bf16 v[32:47], v[64:67], v[48:51], 0
    s_nop 0
    v_mfma_f32_32x32x16_bf16 v[32:47], v[68:71], v[52:55], v[32:47]
    s_nop 0
    v_max3_f32 v104, v16, v17, v18
    v_max3_f32 v105, v19, v20, v21
    v_min3_f32 v106, v16, v17, v18
    v_min3_f32 v107, v19, v20, v21
    v_max3_f32 v104, v104, v22, v23
    v_max3_f32 v105, v105, v24, v25
    v_min3_f32 v106, v106, v22, v23
    v_min3_f32 v107, v107, v24, v25
    v_max3_f32 v104, v104, v26, v27
    v_max3_f32 v105, v105, v28, v29
    v_min3_f32 v106, v106, v26, v27
    v_min3_f32 v107, v107, v28, v29
    v_max3_f32 v104, v104, v30, v31
    v_min3_f32 v106, v106, v30, v31
    v_max_f32 v104, v104, v105
    v_min_f32 v106, v106, v107
    v_mul_f32 v104, s52, v104
    v_mul_f32 v106, s52, v106
    v_pk_fma_f32 v[88:89], v[16:17], s[52:53], v[104:105] op_sel_hi:[1,1,0] neg_lo:[0,0,1] neg_hi:[0,0,1]
    v_pk_fma_f32 v[90:91], v[18:19], s[52:53], v[104:105] op_sel_hi:[1,1,0] neg_lo:[0,0,1] neg_hi:[0,0,1]
    v_pk_fma_f32 v[92:93], v[20:21], s[52:53], v[104:105] op_sel_hi:[1,1,0] neg_lo:[0,0,1] neg_hi:[0,0,1]
    v_pk_fma_f32 v[94:95], v[22:23], s[52:53], v[104:105] op_sel_hi:[1,1,0] neg_lo:[0,0,1] neg_hi:[0,0,1]
    v_pk_fma_f32 v[96:97], v[24:25], s[52:53], v[104:105] op_sel_hi:[1,1,0] neg_lo:[0,0,1] neg_hi:[0,0,1]
    v_pk_fma_f32 v[98:99], v[26:27], s[52:53], v[104:105] op_sel_hi:[1,1,0] neg_lo:[0,0,1] neg_hi:[0,0,1]
    v_pk_fma_f32 v[100:101], v[28:29], s[52:53], v[104:105] op_sel_hi:[1,1,0] neg_lo:[0,0,1] neg_hi:[0,0,1]
    v_pk_fma_f32 v[102:103], v[30:31], s[52:53], v[104:105] op_sel_hi:[1,1,0] neg_lo:[0,0,1] neg_hi:[0,0,1]
    v_pk_fma_f32 v[16:17], v[16:17], s[52:53], v[106:107] op_sel_hi:[1,1,0] neg_lo:[1,0,0] neg_hi:[1,0,0]
    v_pk_fma_f32 v[18:19], v[18:19], s[52:53], v[106:107] op_sel_hi:[1,1,0] neg_lo:[1,0,0] neg_hi:[1,0,0]
    v_pk_fma_f32 v[20:21], v[20:21], s[52:53], v[106:107] op_sel_hi:[1,1,0] neg_lo:[1,0,0] neg_hi:[1,0,0]
    v_pk_fma_f32 v[22:23], v[22:23], s[52:53], v[106:107] op_sel_hi:[1,1,0] neg_lo:[1,0,0] neg_hi:[1,0,0]
    v_pk_fma_f32 v[24:25], v[24:25], s[52:53], v[106:107] op_sel_hi:[1,1,0] neg_lo:[1,0,0] neg_hi:[1,0,0]
    v_pk_fma_f32 v[26:27], v[26:27], s[52:53], v[106:107] op_sel_hi:[1,1,0] neg_lo:[1,0,0] neg_hi:[1,0,0]
L_TA2_0:
    s_cbranch_execz L_TretA
    s_nop 0
    v_pk_fma_f32 v[28:29], v[28:29], s[52:53], v[106:107] op_sel_hi:[1,1,0] neg_lo:[1,0,0] neg_hi:[1,0,0]
    v_pk_fma_f32 v[30:31], v[30:31], s[52:53], v[106:107] op_sel_hi:[1,1,0] neg_lo:[1,0,0] neg_hi:[1,0,0]
    v_max3_f32 v104, v32, v33, v34
    v_max3_f32 v105, v35, v36, v37
    v_min3_f32 v106, v32, v33, v34
    v_min3_f32 v107, v35, v36, v37
    v_max3_f32 v104, v104, v38, v39
    v_max3_f32 v105, v105, v40, v41
    v_min3_f32 v106, v106, v38, v39
    v_min3_f32 v107, v107, v40, v41
    v_max3_f32 v104, v104, v42, v43
    v_max3_f32 v105, v105, v44, v45
    v_min3_f32 v106, v106, v42, v43
    v_min3_f32 v107, v107, v44, v45
    v_max3_f32 v104, v104, v46, v47
    v_min3_f32 v106, v106, v46, v47
    v_max_f32 v104, v104, v105
    v_min_f32 v106, v106, v107
    v_mul_f32 v104, s52, v104
    v_mul_f32 v106, s52, v106
    v_pk_fma_f32 v[128:129], v[32:33], s[52:53], v[104:105] op_sel_hi:[1,1,0] neg_lo:[0,0,1] neg_hi:[0,0,1]
    v_pk_fma_f32 v[130:131], v[34:35], s[52:53], v[104:105] op_sel_hi:[1,1,0] neg_lo:[0,0,1] neg_hi:[0,0,1]
    v_pk_fma_f32 v[132:133], v[36:37], s[52:53], v[104:105] op_sel_hi:[1,1,0] neg_lo:[0,0,1] neg_hi:[0,0,1]
    v_pk_fma_f32 v[134:135], v[38:39], s[52:53], v[104:105] op_sel_hi:[1,1,0] neg_lo:[0,0,1] neg_hi:[0,0,1]
    v_pk_fma_f32 v[136:137], v[40:41], s[52:53], v[104:105] op_sel_hi:[1,1,0] neg_lo:[0,0,1] neg_hi:[0,0,1]
    v_pk_fma_f32 v[138:139], v[42:43], s[52:53], v[104:105] op_sel_hi:[1,1,0] neg_lo:[0,0,1] neg_hi:[0,0,1]
    v_pk_fma_f32 v[140:141], v[44:45], s[52:53], v[104:105] op_sel_hi:[1,1,0] neg_lo:[0,0,1] neg_hi:[0,0,1]
    v_pk_fma_f32 v[142:143], v[46:47], s[52:53], v[104:105] op_sel_hi:[1,1,0] neg_lo:[0,0,1] neg_hi:[0,0,1]
    v_pk_fma_f32 v[32:33], v[32:33], s[52:53], v[106:107] op_sel_hi:[1,1,0] neg_lo:[1,0,0] neg_hi:[1,0,0]
    v_pk_fma_f32 v[34:35], v[34:35], s[52:53], v[106:107] op_sel_hi:[1,1,0] neg_lo:[1,0,0] neg_hi:[1,0,0]
    v_pk_fma_f32 v[36:37], v[36:37], s[52:53], v[106:107] op_sel_hi:[1,1,0] neg_lo:[1,0,0] neg_hi:[1,0,0]
    v_pk_fma_f32 v[38:39], v[38:39], s[52:53], v[106:107] op_sel_hi:[1,1,0] neg_lo:[1,0,0] neg_hi:[1,0,0]
    v_pk_fma_f32 v[40:41], v[40:41], s[52:53], v[106:107] op_sel_hi:[1,1,0] neg_lo:[1,0,0] neg_hi:[1,0,0]
    v_pk_fma_f32 v[42:43], v[42:43], s[52:53], v[106:107] op_sel_hi:[1,1,0] neg_lo:[1,0,0] neg_hi:[1,0,0]
    v_pk_fma_f32 v[44:45], v[44:45], s[52:53], v[106:107] op_sel_hi:[1,1,0] neg_lo:[1,0,0] neg_hi:[1,0,0]
    v_pk_fma_f32 v[46:47], v[46:47], s[52:53], v[106:107] op_sel_hi:[1,1,0] neg_lo:[1,0,0] neg_hi:[1,0,0]
    s_waitcnt vmcnt(0)
    s_barrier
    s_setprio 0
    buffer_load_dwordx2 v[14:15], off, s[36:39], 0 sc1
    buffer_store_dwordx4 v[200:203], v13, s[16:19], s54 offen sc1
    s_mov_b64 exec, 0xffffff
    buffer_store_dwordx4 v[200:203], v204, s[16:19], 0 offen sc1
    s_mov_b64 exec, -1
    v_exp_f32 v88, v88
    v_exp_f32 v89, v89
    v_exp_f32 v90, v90
    v_exp_f32 v91, v91
    v_exp_f32 v92, v92
    v_exp_f32 v93, v93
    v_exp_f32 v94, v94
    v_exp_f32 v95, v95
    v_exp_f32 v96, v96
    v_exp_f32 v97, v97
    v_exp_f32 v98, v98
    v_exp_f32 v99, v99
    v_exp_f32 v100, v100
    v_exp_f32 v101, v101
    v_exp_f32 v102, v102
    v_exp_f32 v103, v103
    v_exp_f32 v16, v16
    v_exp_f32 v17, v17
    v_exp_f32 v18, v18
    v_exp_f32 v19, v19
    v_exp_f32 v20, v20
    v_exp_f32 v21, v21
    v_exp_f32 v22, v22
    v_exp_f32 v23, v23
    v_exp_f32 v24, v24
    v_exp_f32 v25, v25
    v_exp_f32 v26, v26
    v_exp_f32 v27, v27
    v_exp_f32 v28, v28
    v_exp_f32 v29, v29
    v_exp_f32 v30, v30
    v_exp_f32 v31, v31
    v_add_f32 v80, v88, v89
    v_add_f32 v81, v90, v91
    v_add_f32 v84, v16, v17
    v_add_f32 v85, v18, v19
    v_add_f32 v80, v80, v92
    v_add_f32 v81, v81, v93
    v_add_f32 v84, v84, v20
    v_add_f32 v85, v85, v21
    v_add_f32 v80, v80, v94
    v_add_f32 v81, v81, v95
    v_add_f32 v84, v84, v22
    v_add_f32 v85, v85, v23
    v_add_f32 v80, v80, v96
    v_add_f32 v81, v81, v97
    v_add_f32 v84, v84, v24
    v_add_f32 v85, v85, v25
    v_add_f32 v80, v80, v98
    v_add_f32 v81, v81, v99
    v_add_f32 v84, v84, v26
    v_add_f32 v85, v85, v27
    v_add_f32 v80, v80, v100
    v_add_f32 v81, v81, v101
    v_add_f32 v84, v84, v28
    v_add_f32 v85, v85, v29
    v_add_f32 v80, v80, v102
    v_add_f32 v81, v81, v103
    v_add_f32 v84, v84, v30
    v_add_f32 v85, v85, v31
    v_add_f32 v80, v80, v81
    v_add_f32 v84, v84, v85
    v_rcp_f32 v80, v80
    v_rcp_f32 v84, v84
    v_mul_f32 v88, v88, v80
    v_mul_f32 v89, v89, v80
    v_mul_f32 v90, v90, v80
    v_mul_f32 v91, v91, v80
    v_mul_f32 v92, v92, v80
    v_mul_f32 v93, v93, v80
    v_mul_f32 v94, v94, v80
    v_mul_f32 v95, v95, v80
    v_cvt_pk_bf16_f32 v88, v88, v89
    v_cvt_pk_bf16_f32 v89, v90, v91
    v_cvt_pk_bf16_f32 v90, v92, v93
    v_cvt_pk_bf16_f32 v91, v94, v95
    ds_write_b128 v112, v[88:91] offset:0
    v_mul_f32 v96, v96, v80
    v_mul_f32 v97, v97, v80
    v_mul_f32 v98, v98, v80
    v_mul_f32 v99, v99, v80
    v_mul_f32 v100, v100, v80
    v_mul_f32 v101, v101, v80
    v_mul_f32 v102, v102, v80
    v_mul_f32 v103, v103, v80
    v_cvt_pk_bf16_f32 v92, v96, v97
    v_cvt_pk_bf16_f32 v93, v98, v99
    v_cvt_pk_bf16_f32 v94, v100, v101
    v_cvt_pk_bf16_f32 v95, v102, v103
    ds_write_b128 v113, v[92:95] offset:0
    v_mul_f32 v16, v16, v84
    v_mul_f32 v17, v17, v84
    v_mul_f32 v18, v18, v84
    v_mul_f32 v19, v19, v84
    v_mul_f32 v20, v20, v84
    v_mul_f32 v21, v21, v84
    v_mul_f32 v22, v22, v84
    v_mul_f32 v23, v23, v84
    v_cvt_pk_bf16_f32 v16, v16, v17
    v_cvt_pk_bf16_f32 v17, v18, v19
    v_cvt_pk_bf16_f32 v18, v20, v21
    v_cvt_pk_bf16_f32 v19, v22, v23
    ds_write_b128 v114, v[16:19] offset:0
    v_mul_f32 v24, v24, v84
    v_mul_f32 v25, v25, v84
    v_mul_f32 v26, v26, v84
    v_mul_f32 v27, v27, v84
    v_mul_f32 v28, v28, v84
    v_mul_f32 v29, v29, v84
    v_mul_f32 v30, v30, v84
    v_mul_f32 v31, v31, v84
    v_cvt_pk_bf16_f32 v20, v24, v25
    v_cvt_pk_bf16_f32 v21, v26, v27
    v_cvt_pk_bf16_f32 v22, v28, v29
    v_cvt_pk_bf16_f32 v23, v30, v31
    ds_write_b128 v115, v[20:23] offset:0
    s_waitcnt vmcnt(2)
    s_mov_b32 s51, 0
    v_readfirstlane_b32 s50, v15
    v_readfirstlane_b32 s47, v14
    s_cmp_eq_u32 s50, 0
    s_cbranch_scc0 L_o_7
L_o_7_r:
    s_add_u32 s51, s51, 1
    s_cmp_gt_u32 s51, 0x10000
    s_cbranch_scc1 L_o_7
    s_sleep 4
    buffer_load_dwordx2 v[14:15], off, s[36:39], 0 sc1
    s_waitcnt vmcnt(0)
    v_readfirstlane_b32 s50, v15
    v_readfirstlane_b32 s47, v14
    s_cmp_eq_u32 s50, 0
    s_cbranch_scc1 L_o_7_r
L_o_7:
    v_lshlrev_b32 v15, 2, v0
    v_exp_f32 v128, v128
    v_exp_f32 v129, v129
    v_exp_f32 v130, v130
    v_exp_f32 v131, v131
    v_exp_f32 v132, v132
    v_exp_f32 v133, v133
    v_exp_f32 v134, v134
    v_exp_f32 v135, v135
    v_exp_f32 v136, v136
    v_exp_f32 v137, v137
    v_exp_f32 v138, v138
    v_exp_f32 v139, v139
    v_exp_f32 v140, v140
    v_exp_f32 v141, v141
    v_exp_f32 v142, v142
    v_exp_f32 v143, v143
    v_exp_f32 v32, v32
    v_exp_f32 v33, v33
    v_exp_f32 v34, v34
    v_exp_f32 v35, v35
    v_exp_f32 v36, v36
    v_exp_f32 v37, v37
    v_exp_f32 v38, v38
    v_exp_f32 v39, v39
    v_exp_f32 v40, v40
    v_exp_f32 v41, v41
    v_exp_f32 v42, v42
    v_exp_f32 v43, v43
    v_exp_f32 v44, v44
    v_exp_f32 v45, v45
    v_exp_f32 v46, v46
    v_exp_f32 v47, v47
    v_add_f32 v80, v128, v129
    v_add_f32 v81, v130, v131
    v_add_f32 v84, v32, v33
    v_add_f32 v85, v34, v35
    v_add_f32 v80, v80, v132
    v_add_f32 v81, v81, v133
    v_add_f32 v84, v84, v36
    v_add_f32 v85, v85, v37
    v_add_f32 v80, v80, v134
    v_add_f32 v81, v81, v135
    v_add_f32 v84, v84, v38
    v_add_f32 v85, v85, v39
    v_add_f32 v80, v80, v136
    v_add_f32 v81, v81, v137
    v_add_f32 v84, v84, v40
    v_add_f32 v85, v85, v41
    v_add_f32 v80, v80, v138
    v_add_f32 v81, v81, v139
    v_add_f32 v84, v84, v42
    v_add_f32 v85, v85, v43
    v_add_f32 v80, v80, v140
    v_add_f32 v81, v81, v141
    v_add_f32 v84, v84, v44
    v_add_f32 v85, v85, v45
    v_add_f32 v80, v80, v142
    v_add_f32 v81, v81, v143
    v_add_f32 v84, v84, v46
    v_add_f32 v85, v85, v47
    v_add_f32 v80, v80, v81
    v_add_f32 v84, v84, v85
    v_rcp_f32 v80, v80
    v_rcp_f32 v84, v84
    v_mul_f32 v128, v128, v80
    v_mul_f32 v129, v129, v80
    v_mul_f32 v130, v130, v80
    v_mul_f32 v131, v131, v80
    v_mul_f32 v132, v132, v80
    v_mul_f32 v133, v133, v80
    v_mul_f32 v134, v134, v80
    v_mul_f32_e64 v135, v135, v80
    v_cvt_pk_bf16_f32 v128, v128, v129
    v_cvt_pk_bf16_f32 v129, v130, v131
    v_cvt_pk_bf16_f32 v130, v132, v133
    v_cvt_pk_bf16_f32 v131, v134, v135
    ds_write_b128 v112, v[128:131] offset:16384
    v_mul_f32 v136, v136, v80
    v_mul_f32 v137, v137, v80
    v_mul_f32 v138, v138, v80
    v_mul_f32 v139, v139, v80
    v_mul_f32 v140, v140, v80
    v_mul_f32 v141, v141, v80
    v_mul_f32 v142, v142, v80
    v_mul_f32 v143, v143, v80
    v_cvt_pk_bf16_f32 v132, v136, v137
    v_cvt_pk_bf16_f32 v133, v138, v139
    v_cvt_pk_bf16_f32 v134, v140, v141
    v_cvt_pk_bf16_f32 v135, v142, v143
    ds_write_b128 v113, v[132:135] offset:16384
    v_mul_f32 v32, v32, v84
    v_mul_f32 v33, v33, v84
    v_mul_f32 v34, v34, v84
    v_mul_f32 v35, v35, v84
    v_mul_f32 v36, v36, v84
    v_mul_f32 v37, v37, v84
    v_mul_f32 v38, v38, v84
    v_mul_f32 v39, v39, v84
    v_cvt_pk_bf16_f32 v32, v32, v33
    v_cvt_pk_bf16_f32 v33, v34, v35
    v_cvt_pk_bf16_f32 v34, v36, v37
    v_cvt_pk_bf16_f32 v35, v38, v39
    ds_write_b128 v114, v[32:35] offset:16384
    v_mul_f32 v40, v40, v84
    v_mul_f32 v41, v41, v84
    v_mul_f32 v42, v42, v84
    v_mul_f32 v43, v43, v84
    v_mul_f32 v44, v44, v84
    v_mul_f32 v45, v45, v84
    v_mul_f32 v46, v46, v84
    v_mul_f32 v47, v47, v84
    v_cvt_pk_bf16_f32 v36, v40, v41
    v_cvt_pk_bf16_f32 v37, v42, v43
    v_cvt_pk_bf16_f32 v38, v44, v45
    v_cvt_pk_bf16_f32 v39, v46, v47
    ds_write_b128 v115, v[36:39] offset:16384
    s_waitcnt vmcnt(0)
    s_mov_b32 exec_hi, 0
    buffer_store_dword v14, v15, s[16:19], s3 offen sc1
    s_mov_b64 exec, -1
    s_waitcnt lgkmcnt(0)
    s_barrier
    s_setprio 1
    ds_read_b64_tr_b16 v[144:145], v118 offset:0
    ds_read_b64_tr_b16 v[146:147], v118 offset:1024
    ds_read_b64_tr_b16 v[148:149], v122 offset:0
    ds_read_b64_tr_b16 v[150:151], v122 offset:1024
    ds_read_b64_tr_b16 v[176:177], v119 offset:0
    ds_read_b64_tr_b16 v[178:179], v119 offset:1024
    ds_read_b64_tr_b16 v[152:153], v118 offset:2048
    ds_read_b64_tr_b16 v[154:155], v118 offset:3072
    ds_read_b64_tr_b16 v[156:157], v122 offset:2048
    ds_read_b64_tr_b16 v[158:159], v122 offset:3072
    ds_read_b64_tr_b16 v[180:181], v119 offset:2048
    ds_read_b64_tr_b16 v[182:183], v119 offset:3072
    ds_read_b64_tr_b16 v[160:161], v118 offset:4096
    ds_read_b64_tr_b16 v[162:163], v118 offset:5120
    ds_read_b64_tr_b16 v[164:165], v122 offset:4096
    ds_read_b64_tr_b16 v[166:167], v122 offset:5120
    ds_read_b64_tr_b16 v[184:185], v119 offset:4096
    ds_read_b64_tr_b16 v[186:187], v119 offset:5120
    ds_read_b64_tr_b16 v[168:169], v118 offset:6144
    ds_read_b64_tr_b16 v[170:171], v118 offset:7168
    ds_read_b64_tr_b16 v[172:173], v122 offset:6144
    ds_read_b64_tr_b16 v[174:175], v122 offset:7168
    ds_read_b64_tr_b16 v[188:189], v119 offset:6144
    ds_read_b64_tr_b16 v[190:191], v119 offset:7168
    s_waitcnt lgkmcnt(15)
    v_mfma_f32_16x16x32_bf16 v[16:19], v[144:147], v[176:179], 0
    v_mfma_f32_16x16x32_bf16 v[20:23], v[148:151], v[176:179], 0
    v_mfma_f32_16x16x32_bf16 v[48:51], v[144:147], v[60:63], 0
    v_mfma_f32_16x16x32_bf16 v[52:55], v[148:151], v[60:63], 0
    s_waitcnt lgkmcnt(12)
    v_mfma_f32_16x16x32_bf16 v[16:19], v[152:155], v[180:183], v[16:19]
    v_mfma_f32_16x16x32_bf16 v[20:23], v[156:159], v[180:183], v[20:23]
    v_mfma_f32_16x16x32_bf16 v[48:51], v[152:155], v[60:63], v[48:51]
    v_mfma_f32_16x16x32_bf16 v[52:55], v[156:159], v[60:63], v[52:55]
    s_waitcnt lgkmcnt(6)
    v_mfma_f32_16x16x32_bf16 v[16:19], v[160:163], v[184:187], v[16:19]
    v_mfma_f32_16x16x32_bf16 v[20:23], v[164:167], v[184:187], v[20:23]
    v_mfma_f32_16x16x32_bf16 v[48:51], v[160:163], v[60:63], v[48:51]
    v_mfma_f32_16x16x32_bf16 v[52:55], v[164:167], v[60:63], v[52:55]
    s_waitcnt lgkmcnt(0)
    v_mfma_f32_16x16x32_bf16 v[16:19], v[168:171], v[188:191], v[16:19]
    v_mfma_f32_16x16x32_bf16 v[20:23], v[172:175], v[188:191], v[20:23]
    v_mfma_f32_16x16x32_bf16 v[48:51], v[168:171], v[60:63], v[48:51]
    v_mfma_f32_16x16x32_bf16 v[52:55], v[172:175], v[60:63], v[52:55]
    s_nop 4
    v_cvt_pk_bf16_f32 v16, v16, v17
    v_cvt_pk_bf16_f32 v17, v18, v19
    v_cvt_pk_bf16_f32 v18, v20, v21
    v_cvt_pk_bf16_f32 v19, v22, v23
    s_nop 0
    v_permlane16_swap_b32 v16, v18
    v_permlane16_swap_b32 v17, v19
    buffer_store_dwordx4 v[16:19], v120, s[16:19], s54 offen sc1
    v_cvt_pk_bf16_f32 v48, v48, v49
    v_cvt_pk_bf16_f32 v49, v50, v51
    v_cvt_pk_bf16_f32 v50, v52, v53
    v_cvt_pk_bf16_f32 v51, v54, v55
    s_nop 0
    v_permlane16_swap_b32 v48, v50
    v_permlane16_swap_b32 v49, v51
    s_mov_b32 exec_lo, 0x10001
    s_mov_b32 exec_hi, 0x10001
    buffer_store_dwordx4 v[48:51], v108, s[16:19], s55 offen sc1
    s_mov_b64 exec, -1
    s_setprio 0
    s_mov_b64 exec, 1
    ds_add_u32 v126, v127 offset:20
    s_mov_b64 exec, -1
    ds_read_b32 v125, v126 offset:20
    s_add_u32 m0, s48, 0x18000
    s_add_u32 s49, s80, 0x40000
    buffer_load_dwordx4 v4, s[24:27], s49 offen lds
    s_add_u32 m0, s48, 0x17000
    s_add_u32 s49, s80, 0x40000
    buffer_load_dwordx4 v124, s[24:27], s49 offen lds
    s_add_u32 m0, s48, 0x1a000
    s_add_u32 s49, s81, 0x40000
    buffer_load_dwordx4 v4, s[24:27], s49 offen lds
    s_add_u32 m0, s48, 0x19000
    s_add_u32 s49, s81, 0x40000
    buffer_load_dwordx4 v124, s[24:27], s49 offen lds
    s_waitcnt lgkmcnt(0)
    v_readfirstlane_b32 s50, v125
    s_cmp_lt_u32 s50, 4
    s_cbranch_scc0 L_o_8
L_o_8_r:
    s_sleep 1
    ds_read_b32 v125, v126 offset:20
    s_waitcnt lgkmcnt(0)
    v_readfirstlane_b32 s50, v125
    s_cmp_lt_u32 s50, 4
    s_cbranch_scc1 L_o_8_r
L_o_8:
    s_add_u32 m0, s48, 0x10000
    s_nop 0
    buffer_load_dwordx4 v4, s[24:27], s80 offen lds
    s_add_u32 m0, s48, 0xf000
    s_nop 0
    buffer_load_dwordx4 v124, s[24:27], s80 offen lds
    s_add_u32 m0, s48, 0x12000
    s_nop 0
    buffer_load_dwordx4 v4, s[24:27], s81 offen lds
    s_add_u32 m0, s48, 0x11000
    s_nop 0
    buffer_load_dwordx4 v124, s[24:27], s81 offen lds
    s_add_u32 m0, s48, 0x14000
    s_nop 0
    buffer_load_dwordx4 v4, s[24:27], s82 offen lds
    s_add_u32 m0, s48, 0x13000
    s_nop 0
    buffer_load_dwordx4 v124, s[24:27], s82 offen lds
    s_add_u32 m0, s48, 0x16000
    s_nop 0
    buffer_load_dwordx4 v4, s[24:27], s83 offen lds
    s_add_u32 m0, s48, 0x15000
    s_nop 0
    buffer_load_dwordx4 v124, s[24:27], s83 offen lds
    buffer_load_dword v110, v123, s[16:19], s4 offen sc1
    s_add_u32 m0, s48, 0x1c000
    s_add_u32 s49, s82, 0x40000
    buffer_load_dwordx4 v4, s[24:27], s49 offen lds
    s_add_u32 m0, s48, 0x1b000
    s_add_u32 s49, s82, 0x40000
    buffer_load_dwordx4 v124, s[24:27], s49 offen lds
    s_add_u32 m0, s48, 0x1e000
    s_add_u32 s49, s83, 0x40000
    buffer_load_dwordx4 v4, s[24:27], s49 offen lds
    s_add_u32 m0, s48, 0x1d000
    s_add_u32 s49, s83, 0x40000
    buffer_load_dwordx4 v124, s[24:27], s49 offen lds
    s_and_b32 s79, s40, 1
    s_bfe_u32 s77, s40, 0x10001
    s_lshl_b32 s78, s45, 1
    s_add_u32 s78, s78, s79
    s_lshl_b32 s50, s78, 2
    s_lshr_b32 s51, s40, 1
    s_add_u32 s50, s50, s51
    s_lshl_b32 s50, s50, 14
    s_lshr_b32 s51, s80, 16
    s_lshl_b32 s51, s51, 12
    s_add_u32 s72, s50, s51
    s_lshr_b32 s51, s81, 16
    s_lshl_b32 s51, s51, 12
    s_add_u32 s73, s50, s51
    s_lshr_b32 s51, s82, 16
    s_lshl_b32 s51, s51, 12
    s_add_u32 s74, s50, s51
    s_lshr_b32 s51, s83, 16
    s_lshl_b32 s51, s51, 12
    s_add_u32 s75, s50, s51
    s_lshl_b32 s68, s78, 12
    s_lshl_b32 s50, s85, 18
    s_add_u32 s68, s68, s50
    s_add_u32 s68, s68, 0x560000
    s_lshl_b32 s76, s45, 6
    s_and_b32 s50, s40, 6
    s_lshl_b32 s50, s50, 3
    s_add_u32 s76, s76, s50
    s_add_u32 s76, s76, s79
    s_lshl_b32 s76, s76, 10
    s_lshl_b32 s50, s46, 7
    s_add_u32 s76, s76, s50
    v_and_b32 v40, 15, v0
    v_lshrrev_b32 v41, 4, v0
    v_lshlrev_b32_e64 v40, 4, v40
    v_lshl_add_u32 v119, v41, 9, v40
    v_bfe_u32 v40, v0, 2, 3
    v_lshrrev_b32 v41, 5, v0
    v_lshl_add_u32 v40, v41, 4, v40
    v_lshlrev_b32 v40, 7, v40
    v_bfe_u32 v41, v0, 3, 1
    v_lshl_add_u32 v40, v41, 6, v40
    v_bfe_u32 v41, v0, 4, 1
    v_lshl_add_u32 v40, v41, 5, v40
    v_and_b32 v41, 3, v0
    v_lshl_add_u32 v112, v41, 3, v40
    s_lshr_b32 s50, s40, 1
    s_lshl_b32 s50, s50, 15
    v_add_u32 v112, s50, v112
    v_xor_b32 v113, 64, v112
    v_xor_b32 v115, 32, v112
    v_xor_b32 v118, 32, v113
    s_add_u32 s64, s5, 0
    s_add_u32 s65, s5, 4096
    s_add_u32 s66, s5, 8192
    s_add_u32 s67, s5, 12288
    s_waitcnt vmcnt(4)
    v_cmp_ne_u32 vcc, s47, v110
    s_mov_b32 s51, 1
    s_cbranch_vccz L_o_9
L_o_9_r:
    s_add_u32 s51, s51, 1
    s_cmp_gt_u32 s51, 0x10000
    s_cbranch_scc1 L_o_9
    s_sleep 2
    buffer_load_dword v110, v123, s[16:19], s4 offen sc1
    s_waitcnt vmcnt(0)
    v_cmp_ne_u32_e64 vcc, s47, v110
    s_nop 0
    s_cbranch_vccnz L_o_9_r
L_o_9:
    buffer_load_dwordx4 v[32:35], v111, s[16:19], s43 offen sc1
    buffer_load_dwordx4 v[128:131], v121, s[16:19], s64 offen offset:0 sc1
    buffer_load_dwordx4 v[132:135], v121, s[16:19], s64 offen offset:256 sc1
    buffer_load_dwordx4 v[136:139], v121, s[16:19], s64 offen offset:512 sc1
    buffer_load_dwordx4 v[140:143], v121, s[16:19], s64 offen offset:768 sc1
    buffer_load_dwordx4 v[144:147], v121, s[16:19], s65 offen offset:0 sc1
    buffer_load_dwordx4 v[148:151], v121, s[16:19], s65 offen offset:256 sc1
    buffer_load_dwordx4 v[152:155], v121, s[16:19], s65 offen offset:512 sc1
    buffer_load_dwordx4 v[156:159], v121, s[16:19], s65 offen offset:768 sc1
    buffer_load_dwordx4 v[160:163], v121, s[16:19], s66 offen offset:0 sc1
    buffer_load_dwordx4 v[164:167], v121, s[16:19], s66 offen offset:256 sc1
    buffer_load_dwordx4 v[168:171], v121, s[16:19], s66 offen offset:512 sc1
    buffer_load_dwordx4 v[172:175], v121, s[16:19], s66 offen offset:768 sc1
    buffer_load_dwordx4 v[176:179], v121, s[16:19], s67 offen offset:0 sc1
    buffer_load_dwordx4 v[180:183], v121, s[16:19], s67 offen offset:256 sc1
    buffer_load_dwordx4 v[184:187], v121, s[16:19], s67 offen offset:512 sc1
    buffer_load_dwordx4 v[188:191], v121, s[16:19], s67 offen offset:768 sc1
    s_setprio 1
    s_waitcnt vmcnt(16)
    v_max3_u32 v125, v32, v33, v34
    v_max_u32 v125, v125, v35
    v_cmp_eq_u32 vcc, -1, v125
    s_mov_b32 s51, 0
    s_cbranch_vccz L_o_10
L_o_10_r:
    s_add_u32 s51, s51, 1
    s_cmp_gt_u32 s51, 0x10000
    s_cbranch_scc1 L_o_10
    buffer_load_dwordx4 v[32:35], v111, s[16:19], s43 offen sc1
    s_waitcnt vmcnt(0)
    v_max3_u32 v125, v32, v33, v34
    v_max_u32 v125, v125, v35
    v_cmp_eq_u32 vcc, -1, v125
    s_nop 0
    s_cbranch_vccnz L_o_10_r
L_o_10:
    v_mfma_f32_16x16x32_bf16 v[36:39], v[56:59], v[32:35], 0
    s_waitcnt vmcnt(12)
    v_max3_u32 v125, v128, v129, v130
    v_max3_u32 v125, v125, v131, v132
    v_max3_u32 v125, v125, v133, v134
    v_max3_u32 v125, v125, v135, v136
    v_max3_u32 v125, v125, v137, v138
    v_max3_u32 v125, v125, v139, v140
    v_max3_u32 v125, v125, v141, v142
    v_max_u32 v125, v125, v143
    v_cmp_eq_u32 vcc, -1, v125
    s_mov_b32 s51, 0
    s_cbranch_vccz L_o_11
L_o_11_r:
    s_add_u32 s51, s51, 1
    s_cmp_gt_u32 s51, 0x10000
    s_cbranch_scc1 L_o_11
    buffer_load_dwordx4 v[128:131], v121, s[16:19], s64 offen offset:0 sc1
    buffer_load_dwordx4 v[132:135], v121, s[16:19], s64 offen offset:256 sc1
    buffer_load_dwordx4 v[136:139], v121, s[16:19], s64 offen offset:512 sc1
    buffer_load_dwordx4 v[140:143], v121, s[16:19], s64 offen offset:768 sc1
    s_waitcnt vmcnt(0)
    v_max3_u32 v125, v128, v129, v130
    v_max3_u32 v125, v125, v131, v132
    v_max3_u32 v125, v125, v133, v134
    v_max3_u32 v125, v125, v135, v136
    v_max3_u32 v125, v125, v137, v138
    v_max3_u32 v125, v125, v139, v140
    v_max3_u32 v125, v125, v141, v142
    v_max_u32 v125, v125, v143
    v_cmp_eq_u32_e64 vcc, -1, v125
    s_nop 0
    s_cbranch_vccnz L_o_11_r
L_o_11:
    v_mfma_f32_16x16x32_bf16 v[16:19], v[56:59], v[128:131], 0
    v_mfma_f32_16x16x32_bf16 v[20:23], v[56:59], v[132:135], 0
    v_mfma_f32_16x16x32_bf16 v[24:27], v[56:59], v[136:139], 0
    v_mfma_f32_16x16x32_bf16 v[28:31], v[56:59], v[140:143], 0
    s_waitcnt vmcnt(8)
    v_max3_u32 v125, v144, v145, v146
    v_max3_u32 v125, v125, v147, v148
    v_max3_u32 v125, v125, v149, v150
    v_max3_u32 v125, v125, v151, v152
    v_max3_u32 v125, v125, v153, v154
    v_max3_u32 v125, v125, v155, v156
    v_max3_u32 v125, v125, v157, v158
    v_max_u32 v125, v125, v159
    v_cmp_eq_u32 vcc, -1, v125
    s_mov_b32 s51, 0
    s_cbranch_vccz L_o_12
L_o_12_r:
    s_add_u32 s51, s51, 1
    s_cmp_gt_u32 s51, 0x10000
    s_cbranch_scc1 L_o_12
    buffer_load_dwordx4 v[144:147], v121, s[16:19], s65 offen offset:0 sc1
    buffer_load_dwordx4 v[148:151], v121, s[16:19], s65 offen offset:256 sc1
    buffer_load_dwordx4 v[152:155], v121, s[16:19], s65 offen offset:512 sc1
    buffer_load_dwordx4 v[156:159], v121, s[16:19], s65 offen offset:768 sc1
    s_waitcnt vmcnt(0)
    v_max3_u32 v125, v144, v145, v146
    v_max3_u32 v125, v125, v147, v148
    v_max3_u32 v125, v125, v149, v150
    v_max3_u32 v125, v125, v151, v152
    v_max3_u32 v125, v125, v153, v154
    v_max3_u32 v125, v125, v155, v156
    v_max3_u32 v125, v125, v157, v158
    v_max_u32 v125, v125, v159
    v_cmp_eq_u32 vcc, -1, v125
    s_nop 0
    s_cbranch_vccnz L_o_12_r
L_o_12:
    v_mfma_f32_16x16x32_bf16 v[16:19], v[56:59], v[144:147], v[16:19]
    v_mfma_f32_16x16x32_bf16 v[20:23], v[56:59], v[148:151], v[20:23]
    v_mfma_f32_16x16x32_bf16 v[24:27], v[56:59], v[152:155], v[24:27]
    v_mfma_f32_16x16x32_bf16 v[28:31], v[56:59], v[156:159], v[28:31]
    v_add_f32_dpp v36, v36, v36 row_ror:4 row_mask:0xf bank_mask:0xf
    v_add_f32_dpp v37, v37, v37 row_ror:4 row_mask:0xf bank_mask:0xf
    v_add_f32_dpp v38, v38, v38 row_ror:4 row_mask:0xf bank_mask:0xf
    v_add_f32_dpp v39, v39, v39 row_ror:4 row_mask:0xf bank_mask:0xf
    v_add_f32_dpp v36, v36, v36 row_ror:8 row_mask:0xf bank_mask:0xf
    v_add_f32_dpp v37, v37, v37 row_ror:8 row_mask:0xf bank_mask:0xf
    v_add_f32_dpp v38, v38, v38 row_ror:8 row_mask:0xf bank_mask:0xf
    v_add_f32_dpp v39, v39, v39 row_ror:8 row_mask:0xf bank_mask:0xf
    v_cvt_pk_bf16_f32 v36, v36, v37
    v_cvt_pk_bf16_f32 v37, v38, v39
    s_waitcnt vmcnt(4)
    v_max3_u32 v125, v160, v161, v162
    v_max3_u32 v125, v125, v163, v164
    v_max3_u32 v125, v125, v165, v166
    v_max3_u32 v125, v125, v167, v168
    v_max3_u32 v125, v125, v169, v170
    v_max3_u32 v125, v125, v171, v172
    v_max3_u32 v125, v125, v173, v174
    v_max_u32 v125, v125, v175
    v_cmp_eq_u32 vcc, -1, v125
    s_mov_b32 s51, 0
    s_cbranch_vccz L_o_13
L_o_13_r:
    s_add_u32 s51, s51, 1
    s_cmp_gt_u32 s51, 0x10000
    s_cbranch_scc1 L_o_13
    buffer_load_dwordx4 v[160:163], v121, s[16:19], s66 offen offset:0 sc1
    buffer_load_dwordx4 v[164:167], v121, s[16:19], s66 offen offset:256 sc1
    buffer_load_dwordx4 v[168:171], v121, s[16:19], s66 offen offset:512 sc1
    buffer_load_dwordx4 v[172:175], v121, s[16:19], s66 offen offset:768 sc1
    s_waitcnt vmcnt(0)
    v_max3_u32 v125, v160, v161, v162
    v_max3_u32 v125, v125, v163, v164
    v_max3_u32 v125, v125, v165, v166
    v_max3_u32 v125, v125, v167, v168
    v_max3_u32 v125, v125, v169, v170
    v_max3_u32 v125, v125, v171, v172
    v_max3_u32 v125, v125, v173, v174
    v_max_u32 v125, v125, v175
    v_cmp_eq_u32 vcc, -1, v125
    s_nop 0
    s_cbranch_vccnz L_o_13_r
L_o_13:
    v_mfma_f32_16x16x32_bf16 v[16:19], v[56:59], v[160:163], v[16:19]
    v_mfma_f32_16x16x32_bf16 v[20:23], v[56:59], v[164:167], v[20:23]
    v_mfma_f32_16x16x32_bf16 v[24:27], v[56:59], v[168:171], v[24:27]
    v_mfma_f32_16x16x32_bf16 v[28:31], v[56:59], v[172:175], v[28:31]
    s_waitcnt vmcnt(0)
    v_max3_u32 v125, v176, v177, v178
    v_max3_u32 v125, v125, v179, v180
    v_max3_u32 v125, v125, v181, v182
    v_max3_u32 v125, v125, v183, v184
    v_max3_u32 v125, v125, v185, v186
    v_max3_u32 v125, v125, v187, v188
    v_max3_u32 v125, v125, v189, v190
    v_max_u32 v125, v125, v191
    v_cmp_eq_u32 vcc, -1, v125
    s_mov_b32 s51, 0
    s_cbranch_vccz L_o_14
L_o_14_r:
    s_add_u32 s51, s51, 1
    s_cmp_gt_u32 s51, 0x10000
    s_cbranch_scc1 L_o_14
    buffer_load_dwordx4 v[176:179], v121, s[16:19], s67 offen offset:0 sc1
    buffer_load_dwordx4 v[180:183], v121, s[16:19], s67 offen offset:256 sc1
    buffer_load_dwordx4 v[184:187], v121, s[16:19], s67 offen offset:512 sc1
    buffer_load_dwordx4 v[188:191], v121, s[16:19], s67 offen offset:768 sc1
    s_waitcnt vmcnt(0)
    v_max3_u32 v125, v176, v177, v178
    v_max3_u32 v125, v125, v179, v180
    v_max3_u32 v125, v125, v181, v182
    v_max3_u32 v125, v125, v183, v184
    v_max3_u32 v125, v125, v185, v186
    v_max3_u32 v125, v125, v187, v188
    v_max3_u32 v125, v125, v189, v190
    v_max_u32 v125, v125, v191
    v_cmp_eq_u32 vcc, -1, v125
    s_nop 0
    s_cbranch_vccnz L_o_14_r
L_o_14:
    v_mfma_f32_16x16x32_bf16 v[16:19], v[56:59], v[176:179], v[16:19]
    v_mfma_f32_16x16x32_bf16 v[20:23], v[56:59], v[180:183], v[20:23]
    v_mfma_f32_16x16x32_bf16 v[24:27], v[56:59], v[184:187], v[24:27]
    v_mfma_f32_16x16x32_bf16 v[28:31], v[56:59], v[188:191], v[28:31]
    s_mov_b32 exec_hi, 0
    ds_write_b64 v117, v[36:37]
    s_nop 2
    v_cvt_pk_bf16_f32 v16, v16, v17
    v_cvt_pk_bf16_f32 v17, v18, v19
    ds_write_b64 v116, v[16:17] offset:0
    v_cvt_pk_bf16_f32 v20, v20, v21
    v_cvt_pk_bf16_f32 v21, v22, v23
    ds_write_b64 v116, v[20:21] offset:256
    v_cvt_pk_bf16_f32 v24, v24, v25
    v_cvt_pk_bf16_f32 v25, v26, v27
    ds_write_b64 v116, v[24:25] offset:576
L_TA0_1:
    s_cbranch_execz L_TretA
    s_nop 0
    v_cvt_pk_bf16_f32 v28, v28, v29
    v_cvt_pk_bf16_f32 v29, v30, v31
    ds_write_b64 v116, v[28:29] offset:832
    s_mov_b64 exec, -1
    s_setprio 0
    s_mov_b64 exec, 1
    ds_add_u32 v126, v127 offset:12
    s_mov_b64 exec, -1
    s_waitcnt vmcnt(0)
    s_mov_b64 exec, 1
    ds_add_u32 v126, v127 offset:16
    s_mov_b64 exec, -1
    ds_read_b32 v125, v126 offset:0
    s_add_u32 m0, s48, 0x0
    s_nop 0
    buffer_load_dwordx4 v4, s[20:23], s80 offen lds
    s_add_u32 m0, s48, 0xfffff000
    s_nop 0
    buffer_load_dwordx4 v124, s[20:23], s80 offen lds
    s_add_u32 m0, s48, 0x2000
    s_nop 0
    buffer_load_dwordx4 v4, s[20:23], s81 offen lds
    s_add_u32 m0, s48, 0x1000
    s_nop 0
    buffer_load_dwordx4 v124, s[20:23], s81 offen lds
    s_add_u32 m0, s48, 0x4000
    s_nop 0
    buffer_load_dwordx4 v4, s[20:23], s82 offen lds
    s_add_u32 m0, s48, 0x3000
    s_nop 0
    buffer_load_dwordx4 v124, s[20:23], s82 offen lds
    s_waitcnt lgkmcnt(0)
    v_readfirstlane_b32 s50, v125
    s_cmp_lt_u32 s50, 4
    s_cbranch_scc0 L_o_15
L_o_15_r:
    s_sleep 1
    ds_read_b32 v125, v126 offset:0
    s_waitcnt lgkmcnt(0)
    v_readfirstlane_b32 s50, v125
    s_cmp_lt_u32 s50, 4
    s_cbranch_scc1 L_o_15_r
L_o_15:
    s_add_u32 m0, s48, 0x6000
    s_nop 0
    buffer_load_dwordx4 v4, s[20:23], s83 offen lds
    s_add_u32 m0, s48, 0x5000
    s_nop 0
    buffer_load_dwordx4 v124, s[20:23], s83 offen lds
    s_add_u32 m0, s48, 0x8000
    s_add_u32 s49, s80, 0x40000
    buffer_load_dwordx4 v4, s[20:23], s49 offen lds
    s_add_u32 m0, s48, 0x7000
    s_add_u32 s49, s80, 0x40000
    buffer_load_dwordx4 v124, s[20:23], s49 offen lds
    ds_read_b32 v125, v126 offset:16
    v_and_b32 v11, 7, v0
    s_lshl_b32 s50, s77, 3
    v_add_u32 v11, s50, v11
    v_and_b32 v12, 1, v0
    v_add_u32 v12, 16, v12
    v_cmp_gt_u32 vcc, 32, v0
    s_nop 1
    v_cndmask_b32 v11, v12, v11, vcc
    v_lshlrev_b32 v11, 7, v11
    buffer_load_dword v12, v11, s[16:19], s68 offen sc1
    v_and_b32 v5, 31, v0
    v_lshlrev_b32 v5, 2, v5
    s_lshl_b32 s69, s78, 7
    s_add_u32 s69, s69, 0x520000
    s_mov_b32 s70, 0
    s_waitcnt lgkmcnt(0)
    v_readfirstlane_b32 s50, v125
    s_cmp_lt_u32 s50, 4
    s_cbranch_scc0 L_o_16
L_o_16_r:
    ds_read_b32 v125, v126 offset:16
    s_waitcnt lgkmcnt(0)
    v_readfirstlane_b32 s50, v125
    s_cmp_lt_u32 s50, 4
    s_cbranch_scc1 L_o_16_r
L_o_16:
    s_branch L_P2B
L_typeB:
    s_mov_b32 s12, s32
    s_mov_b32 s13, s33
    s_and_b32 s50, s40, 1
    s_lshl_b32 s50, s50, 5
    v_xor_b32 v3, s50, v3
    v_xor_b32 v65, 0x8000, v1
    v_xor_b32 v66, 0x8000, v2
    v_add_u32 v67, 0x18000, v3
    s_cmp_eq_u32 s85, 0
    s_cbranch_scc0 L_Bh
    s_add_u32 m0, s48, 0x14000
    s_nop 0
    buffer_load_dwordx4 v1, s[8:11], s64 offen lds
    s_add_u32 m0, s48, 0x15000
    s_nop 0
    buffer_load_dwordx4 v65, s[8:11], s64 offen lds
    s_add_u32 m0, s48, 0x16000
    s_nop 0
    buffer_load_dwordx4 v2, s[8:11], s64 offen lds
    s_add_u32 m0, s48, 0x17000
    s_nop 0
    buffer_load_dwordx4 v66, s[8:11], s64 offen lds
    s_add_u32 m0, s48, 0x18000
    s_add_u32 s49, s72, 0x400
    buffer_load_dwordx4 v3, s[12:15], s49 offen lds
    s_add_u32 m0, s48, 0x19000
    s_add_u32 s49, s72, 0x400
    buffer_load_dwordx4 v67, s[12:15], s49 offen lds
    s_add_u32 m0, s48, 0x1a000
    s_add_u32 s49, s72, 0x800
    buffer_load_dwordx4 v3, s[12:15], s49 offen lds
    s_add_u32 m0, s48, 0x1b000
    s_add_u32 s49, s72, 0x800
    buffer_load_dwordx4 v67, s[12:15], s49 offen lds
    s_add_u32 m0, s48, 0x1c000
    s_nop 0
    buffer_load_dwordx4 v3, s[12:15], s72 offen lds
    s_add_u32 m0, s48, 0x1d000
    s_nop 0
    buffer_load_dwordx4 v67, s[12:15], s72 offen lds
    v_and_b32 v16, 0x3870, v1
    s_lshr_b32 s50, s40, 1
    s_add_u32 s50, s50, s44
    s_and_b32 s50, s50, 7
    s_lshl_b32 s50, s50, 7
    s_lshl_b32 s51, s41, 17
    s_add_u32 s50, s50, s51
    s_and_b32 s51, s40, 1
    s_lshl_b32 s51, s51, 10
    s_add_u32 s50, s50, s51
    s_sub_u32 s50, s50, 0x4000
    v_add_u32 v16, s50, v16
    s_add_u32 m0, s48, 0x1e000
    s_nop 0
    buffer_load_dwordx4 v16, s[8:11], 0 offen lds
    s_barrier
    s_mov_b64 s[20:21], s[30:31]
    s_mov_b64 s[24:25], s[34:35]
    s_mov_b64 s[32:33], s[36:37]
    s_mov_b64 s[28:29], s[38:39]
    s_mov_b64 s[36:37], s[4:5]
    s_mov_b64 s[16:17], s[6:7]
    s_add_u32 s50, s44, 2
    s_and_b32 s50, s50, 7
    s_lshl_b32 s66, s50, 7
    s_add_u32 s66, s66, s54
    s_mul_i32 s74, s50, 0x30000
    s_add_u32 s74, s74, s55
    s_add_u32 s50, s44, 3
    s_and_b32 s50, s50, 7
    s_lshl_b32 s67, s50, 7
    s_add_u32 s67, s67, s54
    s_mul_i32 s75, s50, 0x30000
    s_add_u32 s75, s75, s55
    s_add_u32 s50, s44, 4
    s_and_b32 s50, s50, 7
    s_lshl_b32 s68, s50, 7
    s_add_u32 s68, s68, s54
    s_mul_i32 s76, s50, 0x30000
    s_add_u32 s76, s76, s55
    s_add_u32 s50, s44, 5
    s_and_b32 s50, s50, 7
    s_lshl_b32 s69, s50, 7
    s_add_u32 s69, s69, s54
    s_mul_i32 s77, s50, 0x30000
    s_add_u32 s77, s77, s55
    s_add_u32 s50, s44, 6
    s_and_b32 s50, s50, 7
    s_lshl_b32 s70, s50, 7
    s_add_u32 s70, s70, s54
    s_mul_i32 s78, s50, 0x30000
    s_add_u32 s78, s78, s55
    s_add_u32 s50, s44, 7
    s_and_b32 s50, s50, 7
    s_lshl_b32 s71, s50, 7
    s_add_u32 s71, s71, s54
    s_mul_i32 s79, s50, 0x30000
    s_add_u32 s79, s79, s55
    s_mov_b32 s34, 0x400
    s_mov_b32 s35, 0x20000
    s_mov_b32 s18, 0x10000000
    s_mov_b32 s19, 0x20000
    s_mov_b32 s22, 0x80000
    s_mov_b32 s23, 0x20000
    s_mov_b32 s26, 0x80000
    s_mov_b32 s27, 0x20000
    s_mov_b32 s30, 0x200000
    s_mov_b32 s31, 0x20000
    s_mov_b32 s38, 0x100
    s_mov_b32 s39, 0x20000
    s_lshl_b32 s50, s2, 3
    s_add_u32 s50, s50, s40
    s_cmp_eq_u32 s50, 515
    s_cbranch_scc0 L_notl_17
    s_mov_b32 s50, 0x530000
    s_buffer_load_dword s3, s[16:19], s50
L_notl_17:
    s_and_b32 s54, s40, 1
    s_bfe_u32 s55, s40, 0x10001
    s_mov_b32 s52, 0x3fb8aa3b
    s_mov_b32 s53, 0x3fb8aa3b
    s_add_u32 s50, s45, 0
    s_and_b32 s50, s50, 3
    s_lshl_b32 s50, s50, 16
    s_lshl_b32 s51, s46, 7
    s_add_u32 s80, s50, s51
    s_add_u32 s50, s45, 1
    s_and_b32 s50, s50, 3
    s_lshl_b32 s50, s50, 16
    s_lshl_b32 s51, s46, 7
    s_add_u32 s81, s50, s51
    s_add_u32 s50, s45, 2
    s_and_b32 s50, s50, 3
    s_lshl_b32 s50, s50, 16
    s_lshl_b32 s51, s46, 7
    s_add_u32 s82, s50, s51
    s_add_u32 s50, s45, 3
    s_and_b32 s50, s50, 3
    s_lshl_b32 s50, s50, 16
    s_lshl_b32 s51, s46, 7
    s_add_u32 s83, s50, s51
    v_and_b32 v16, 15, v0
    v_lshrrev_b32 v17, 4, v0
    v_bfe_u32 v18, v0, 1, 3
    v_xor_b32 v18, v17, v18
    v_lshlrev_b32 v18, 4, v18
    v_lshl_add_u32 v18, v16, 7, v18
    s_lshl_b32 s50, s54, 13
    v_add_u32 v5, s50, v18
    v_xor_b32 v6, 64, v5
    v_add_u32 v7, 0x1e000, v18
    v_xor_b32 v8, 64, v7
    v_bfe_u32 v18, v0, 2, 2
    v_lshl_add_u32 v18, v17, 3, v18
    v_lshlrev_b32 v18, 7, v18
    v_bfe_u32 v19, v0, 3, 1
    v_xor_b32 v19, s55, v19
    v_lshl_add_u32 v18, v19, 6, v18
    v_bfe_u32 v19, v0, 4, 1
    v_lshl_add_u32 v18, v19, 5, v18
    v_and_b32_e64 v19, 3, v0
    v_lshl_add_u32 v74, v19, 3, v18
    v_add_u32 v74, 0x4000, v74
    v_xor_b32 v75, 32, v74
    v_add_u32 v9, s50, v74
    v_add_u32 v10, s50, v75
    v_subrev_u32 v11, s50, v74
    v_subrev_u32_e64 v12, s50, v75
    v_add_u32 v1, 0x14000, v5
    v_add_u32 v2, 0x14000, v6
    v_add_u32 v3, 0x14000, v9
    v_add_u32 v64, 0x14000, v10
    v_add_u32 v65, 0x14000, v11
    v_add_u32 v66, 0x14000, v12
    v_add_u32 v67, 0x14000, v74
    v_add_u32 v69, 0x14000, v75
    v_bfe_u32 v18, v0, 1, 2
    v_xor_b32 v19, v17, v18
    v_lshlrev_b32 v19, 4, v19
    v_lshl_add_u32 v19, v16, 6, v19
    s_mul_i32 s50, s55, 9216
    s_mul_i32 s51, s54, 18432
    s_add_u32 s50, s50, s51
    s_add_u32 s50, s50, 0x0
    v_add_u32 v78, s50, v19
    s_lshl_b32 s50, s54, 12
    s_add_u32 s50, s50, 1024
    v_add_u32 v76, s50, v78
    s_lshl_b32 s51, s51, 1
    s_sub_u32 s51, 18432, s51
    v_add_u32 v77, s51, v76
    s_lshl_b32 s50, s54, 12
    s_lshl_b32 s51, s55, 13
    s_add_u32 s50, s50, s51
    s_add_u32 s50, s50, 0x22000
    v_add_u32 v79, s50, v19
    v_mov_b32 v126, 0x26a00
    v_mov_b32 v127, 1
    v_lshrrev_b32 v88, 4, v0
    v_lshlrev_b32 v88, 2, v88
    v_and_b32 v89, 7, v0
    v_sub_u32 v88, v88, v89
    v_mov_b32 v90, 0xf149f2ca
    v_add_u32 v89, -1, v88
    v_cmp_gt_u32 vcc, 8, v89
    s_nop 1
    v_cndmask_b32 v80, v90, 0, vcc
    v_add_u32 v89, 0, v88
    v_cmp_gt_u32 vcc, 8, v89
    s_nop 1
    v_cndmask_b32 v81, v90, 0, vcc
    v_add_u32 v89, 1, v88
    v_cmp_gt_u32 vcc, 8, v89
    s_nop 1
    v_cndmask_b32 v82, v90, 0, vcc
    v_add_u32 v89, 2, v88
    v_cmp_gt_u32 vcc, 8, v89
    s_nop 1
    v_cndmask_b32 v83, v90, 0, vcc
    s_or_b32 s50, s41, s84
    s_cmp_eq_u32 s50, 0
    s_cselect_b32 s50, 32, 0
    v_cmp_gt_u32 vcc, s50, v0
    s_nop 1
    v_cndmask_b32 v84, v80, v90, vcc
    v_cndmask_b32 v85, v81, v90, vcc
    v_cndmask_b32 v86, v82, v90, vcc
    v_cndmask_b32 v87, v83, v90, vcc
    s_mul_i32 s43, s85, 9216
    s_lshl_b32 s50, s84, 11
    s_add_u32 s43, s43, s50
    s_add_u32 s43, s43, 0x0
    v_and_b32 v88, 15, v0
    v_and_b32 v89, 8, v0
    v_add_u32 v88, v88, v89
    v_lshrrev_b32 v89, 4, v0
    v_bfe_u32 v90, v0, 1, 2
    v_xor_b32 v89, v89, v90
    v_lshlrev_b32 v89, 4, v89
    v_and_b32_e64 v91, 7, v0
    v_lshl_add_u32 v91, v91, 6, v89
    v_lshl_add_u32 v88, v88, 6, v89
    v_add_u32 v88, s43, v88
    s_lshl_b32 s50, s85, 13
    s_lshl_b32 s51, s84, 11
    s_add_u32 s50, s50, s51
    s_add_u32 s50, s50, 0x22000
    v_add_u32 v91, s50, v91
    v_lshrrev_b32 v89, 2, v0
    v_and_b32 v90, 8, v89
    v_add_u32 v89, v89, v90
    v_bfe_u32 v90, v0, 3, 2
    v_and_b32 v92, 3, v0
    v_xor_b32 v90, v90, v92
    v_lshlrev_b32_e64 v90, 4, v90
    v_lshl_add_u32 v89, v89, 6, v90
    s_add_u32 s43, s43, 18432
    v_add_u32 v89, s43, v89
    v_bfe_u32 v92, v0, 3, 1
    v_lshlrev_b32 v92, 6, v92
    v_bfe_u32 v93, v0, 4, 1
    v_lshl_add_u32 v92, v93, 5, v92
    v_lshrrev_b32 v93, 5, v0
    v_lshl_add_u32 v92, v93, 3, v92
    v_and_b32 v93, 7, v0
    v_add_u32 v92, v92, v93
    v_lshlrev_b32 v92, 4, v92
    v_mov_b32 v96, 0x3f803f80
    v_mov_b32 v97, 0x3f803f80
    v_mov_b32 v98, 0x3f803f80
    v_mov_b32 v99, 0x3f803f80
    v_mov_b32 v208, 0
    v_mov_b32 v209, 0
    v_mov_b32 v210, 0
    v_mov_b32 v211, 0
    v_mov_b32 v212, 0
    v_mov_b32 v213, 0
    v_mov_b32 v214, 0
    v_mov_b32 v215, 0
    v_mov_b32 v216, 0
    v_mov_b32 v217, 0
    v_mov_b32 v218, 0
    v_mov_b32 v219, 0
    v_mov_b32 v220, 0
    v_mov_b32 v221, 0
    v_mov_b32 v222, 0
    v_mov_b32 v223, 0
    s_lshl_b32 s50, s41, 2
    s_add_u32 s50, s50, s84
    s_lshl_b32 s51, s42, 1
    s_add_u32 s51, s51, s85
    s_lshl_b32 s54, s50, 5
    s_add_u32 s54, s54, s51
    s_lshl_b32 s55, s54, 7
    s_add_u32 s55, s55, 0x5a0000
    s_add_u32 s54, s54, 16
    s_lshl_b32 s54, s54, 11
    s_lshl_b32 s50, s41, 2
    s_lshr_b32 s51, s42, 1
    s_add_u32 s50, s50, s51
    s_lshl_b32 s50, s50, 5
    s_and_b32 s51, s42, 1
    s_add_u32 s50, s50, s51
    s_lshl_b32 s4, s50, 7
    s_add_u32 s4, s4, 0x5a0800
    s_cmp_eq_u32 s40, 4
    s_cselect_b32 s4, s4, 0
    s_lshl_b32 s5, s41, 9
    s_lshl_b32 s51, s42, 6
    s_add_u32 s5, s5, s51
    s_add_u32 s5, s5, 0x520000
    v_xor_b32 v68, 0x8000, v4
    s_mov_b32 s62, 1
    s_mov_b64 exec, 0
    s_cmp_eq_u32 s40, 0
    s_cbranch_scc1 L_TB0_0
    s_cmp_eq_u32 s40, 1
    s_cbranch_scc1 L_TB1_0
    s_cmp_eq_u32 s40, 2
    s_cbranch_scc1 L_TB2_0
    s_branch L_TP0_0
L_TretB:
    s_mov_b64 exec, -1
    s_waitcnt vmcnt(0)
    s_mov_b64 exec, 1
    ds_add_u32 v126, v127 offset:28
    s_mov_b64 exec, -1
    s_lshl_b32 s50, s2, 3
    s_add_u32 s50, s50, s40
    s_cmp_eq_u32 s50, 515
    s_cbranch_scc0 L_notag_18
    s_waitcnt lgkmcnt(0)
    s_add_u32 s50, s3, 0x9e3779b9
    s_and_b32 s50, s50, 0x7fffffff
    v_mov_b32 v16, s50
    v_mov_b32_e64 v17, 1
    s_mov_b64 exec, 1
    buffer_store_dwordx2 v[16:17], off, s[36:39], 0 sc1
    s_mov_b32 s50, 0x530000
    buffer_store_dword v16, off, s[16:19], s50 sc1
    s_mov_b64 exec, -1
L_notag_18:
    ds_read_b32 v125, v126 offset:28
    s_waitcnt lgkmcnt(0)
    v_readfirstlane_b32 s50, v125
    s_cmp_lt_u32 s50, 4
    s_cbranch_scc0 L_m_19
L_m_19_r:
    ds_read_b32 v125, v126 offset:28
    s_waitcnt lgkmcnt(0)
    v_readfirstlane_b32 s50, v125
    s_cmp_lt_u32 s50, 4
    s_cbranch_scc1 L_m_19_r
L_m_19:
    ds_read_b128 v[148:151], v1 offset:0
    ds_read_b128 v[152:155], v1 offset:2048
    ds_read_b64_tr_b16 v[224:225], v3 offset:0
    ds_read_b64_tr_b16 v[226:227], v3 offset:512
    ds_read_b128 v[156:159], v1 offset:4096
    ds_read_b128 v[160:163], v1 offset:6144
    ds_read_b64_tr_b16 v[228:229], v64 offset:0
    ds_read_b64_tr_b16 v[230:231], v64 offset:512
    ds_read_b128 v[252:255], v7 offset:0
    ds_read_b64_tr_b16 v[164:165], v65 offset:8192
    ds_read_b64_tr_b16 v[166:167], v65 offset:8704
    ds_read_b64_tr_b16 v[168:169], v66 offset:8192
    ds_read_b64_tr_b16 v[170:171], v66 offset:8704
    ds_read_b64_tr_b16 v[172:173], v67 offset:16384
    ds_read_b64_tr_b16 v[174:175], v67 offset:16896
    ds_read_b64_tr_b16 v[176:177], v69 offset:16384
    ds_read_b64_tr_b16 v[178:179], v69 offset:16896
    s_waitcnt lgkmcnt(8)
    v_mfma_f32_16x16x32_bf16 v[16:19], v[224:227], v[148:151], 0
    ds_read_b128 v[180:183], v2 offset:0
    v_mfma_f32_16x16x32_bf16 v[24:27], v[224:227], v[152:155], 0
    ds_read_b128 v[184:187], v2 offset:2048
    v_mfma_f32_16x16x32_bf16 v[100:103], v[224:227], v[156:159], 0
    ds_read_b64_tr_b16 v[232:233], v3 offset:4096
    v_mfma_f32_16x16x32_bf16 v[108:111], v[224:227], v[160:163], 0
    v_mfma_f32_16x16x32_bf16 v[20:23], v[228:231], v[148:151], 0
    ds_read_b64_tr_b16 v[234:235], v3 offset:4608
    v_mfma_f32_16x16x32_bf16 v[28:31], v[228:231], v[152:155], 0
    ds_read_b128 v[188:191], v2 offset:4096
    v_mfma_f32_16x16x32_bf16 v[104:107], v[228:231], v[156:159], 0
    v_mfma_f32_16x16x32_bf16 v[112:115], v[228:231], v[160:163], 0
    ds_read_b128 v[192:195], v2 offset:6144
    v_mfma_f32_16x16x32_bf16 v[244:247], v[224:227], v[252:255], 0
    ds_read_b64_tr_b16 v[236:237], v64 offset:4096
    v_mfma_f32_16x16x32_bf16 v[248:251], v[228:231], v[252:255], 0
    ds_read_b64_tr_b16 v[238:239], v64 offset:4608
    s_waitcnt lgkmcnt(12)
    v_mfma_f32_16x16x32_bf16 v[32:35], v[164:167], v[148:151], 0
    v_mfma_f32_16x16x32_bf16 v[40:43], v[164:167], v[152:155], 0
    ds_read_b128 v[70:73], v8 offset:0
    v_mfma_f32_16x16x32_bf16 v[116:119], v[164:167], v[156:159], 0
    ds_read_b64_tr_b16 v[196:197], v65 offset:12288
    v_mfma_f32_16x16x32_bf16 v[124:127], v[164:167], v[160:163], 0
    v_mfma_f32_16x16x32_bf16 v[36:39], v[168:171], v[148:151], 0
    ds_read_b64_tr_b16 v[198:199], v65 offset:12800
    v_mfma_f32_16x16x32_bf16 v[44:47], v[168:171], v[152:155], 0
    ds_read_b64_tr_b16 v[200:201], v66 offset:12288
    v_mfma_f32_16x16x32_bf16 v[120:123], v[168:171], v[156:159], 0
    ds_read_b64_tr_b16 v[202:203], v66 offset:12800
    v_mfma_f32_16x16x32_bf16 v[128:131], v[168:171], v[160:163], 0
    s_waitcnt lgkmcnt(13)
    v_mfma_f32_16x16x32_bf16 v[48:51], v[172:175], v[148:151], 0
    ds_read_b64_tr_b16 v[204:205], v67 offset:20480
    v_mfma_f32_16x16x32_bf16 v[56:59], v[172:175], v[152:155], 0
    ds_read_b64_tr_b16 v[206:207], v67 offset:20992
    v_mfma_f32_16x16x32_bf16 v[132:135], v[172:175], v[156:159], 0
    v_mfma_f32_16x16x32_bf16 v[140:143], v[172:175], v[160:163], 0
    ds_read_b64_tr_b16 v[240:241], v69 offset:20480
    v_mfma_f32_16x16x32_bf16 v[52:55], v[176:179], v[148:151], 0
    ds_read_b64_tr_b16 v[242:243], v69 offset:20992
    v_mfma_f32_16x16x32_bf16 v[60:63], v[176:179], v[152:155], 0
    v_mfma_f32_16x16x32_bf16 v[136:139], v[176:179], v[156:159], 0
    v_mfma_f32_16x16x32_bf16 v[144:147], v[176:179], v[160:163], 0
    s_waitcnt lgkmcnt(8)
    v_mfma_f32_16x16x32_bf16 v[16:19], v[232:235], v[180:183], v[16:19]
    s_waitcnt lgkmcnt(0)
    s_barrier
    ds_read_b128 v[148:151], v5 offset:0
    v_mfma_f32_16x16x32_bf16 v[24:27], v[232:235], v[184:187], v[24:27]
    ds_read_b128 v[152:155], v5 offset:2048
    v_mfma_f32_16x16x32_bf16 v[100:103], v[232:235], v[188:191], v[100:103]
    ds_read_b64_tr_b16 v[224:225], v9 offset:0
    v_mfma_f32_16x16x32_bf16 v[108:111], v[232:235], v[192:195], v[108:111]
    v_mfma_f32_16x16x32_bf16 v[20:23], v[236:239], v[180:183], v[20:23]
    ds_read_b64_tr_b16 v[226:227], v9 offset:512
    v_mfma_f32_16x16x32_bf16 v[28:31], v[236:239], v[184:187], v[28:31]
    ds_read_b128 v[156:159], v5 offset:4096
    v_mfma_f32_16x16x32_bf16 v[104:107], v[236:239], v[188:191], v[104:107]
    v_mfma_f32_16x16x32_bf16 v[112:115], v[236:239], v[192:195], v[112:115]
    ds_read_b128 v[160:163], v5 offset:6144
    v_mfma_f32_16x16x32_bf16 v[244:247], v[232:235], v[70:73], v[244:247]
    ds_read_b64_tr_b16 v[228:229], v10 offset:0
    v_mfma_f32_16x16x32_bf16 v[248:251], v[236:239], v[70:73], v[248:251]
    ds_read_b64_tr_b16 v[230:231], v10 offset:512
    v_mfma_f32_16x16x32_bf16 v[32:35], v[196:199], v[180:183], v[32:35]
    v_mfma_f32_16x16x32_bf16 v[40:43], v[196:199], v[184:187], v[40:43]
    ds_read_b128 v[252:255], v7 offset:2048
    v_mfma_f32_16x16x32_bf16 v[116:119], v[196:199], v[188:191], v[116:119]
    ds_read_b64_tr_b16 v[164:165], v11 offset:8192
    v_mfma_f32_16x16x32_bf16 v[124:127], v[196:199], v[192:195], v[124:127]
    v_mfma_f32_16x16x32_bf16 v[36:39], v[200:203], v[180:183], v[36:39]
    ds_read_b64_tr_b16 v[166:167], v11 offset:8704
    v_mfma_f32_16x16x32_bf16 v[44:47], v[200:203], v[184:187], v[44:47]
    ds_read_b64_tr_b16 v[168:169], v12 offset:8192
    v_mfma_f32_16x16x32_bf16 v[120:123], v[200:203], v[188:191], v[120:123]
    ds_read_b64_tr_b16 v[170:171], v12 offset:8704
    v_mfma_f32_16x16x32_bf16 v[128:131], v[200:203], v[192:195], v[128:131]
    v_mfma_f32_16x16x32_bf16 v[48:51], v[204:207], v[180:183], v[48:51]
    ds_read_b64_tr_b16 v[172:173], v74 offset:16384
    v_mfma_f32_16x16x32_bf16 v[56:59], v[204:207], v[184:187], v[56:59]
    ds_read_b64_tr_b16 v[174:175], v74 offset:16896
    v_mfma_f32_16x16x32_bf16 v[132:135], v[204:207], v[188:191], v[132:135]
    v_mfma_f32_16x16x32_bf16 v[140:143], v[204:207], v[192:195], v[140:143]
    ds_read_b64_tr_b16 v[176:177], v75 offset:16384
    v_mfma_f32_16x16x32_bf16 v[52:55], v[240:243], v[180:183], v[52:55]
    ds_read_b64_tr_b16 v[178:179], v75 offset:16896
    v_mfma_f32_16x16x32_bf16 v[60:63], v[240:243], v[184:187], v[60:63]
    v_mfma_f32_16x16x32_bf16 v[136:139], v[240:243], v[188:191], v[136:139]
    v_mfma_f32_16x16x32_bf16 v[144:147], v[240:243], v[192:195], v[144:147]
    s_waitcnt lgkmcnt(8)
    v_mfma_f32_16x16x32_bf16 v[16:19], v[224:227], v[148:151], v[16:19]
    ds_read_b128 v[180:183], v6 offset:0
    v_mfma_f32_16x16x32_bf16 v[24:27], v[224:227], v[152:155], v[24:27]
    ds_read_b128 v[184:187], v6 offset:2048
    v_mfma_f32_16x16x32_bf16 v[100:103], v[224:227], v[156:159], v[100:103]
    ds_read_b64_tr_b16 v[232:233], v9 offset:4096
    v_mfma_f32_16x16x32_bf16 v[108:111], v[224:227], v[160:163], v[108:111]
    v_mfma_f32_16x16x32_bf16 v[20:23], v[228:231], v[148:151], v[20:23]
    ds_read_b64_tr_b16 v[234:235], v9 offset:4608
    v_mfma_f32_16x16x32_bf16 v[28:31], v[228:231], v[152:155], v[28:31]
    ds_read_b128 v[188:191], v6 offset:4096
    v_mfma_f32_16x16x32_bf16 v[104:107], v[228:231], v[156:159], v[104:107]
    v_mfma_f32_16x16x32_bf16 v[112:115], v[228:231], v[160:163], v[112:115]
    ds_read_b128 v[192:195], v6 offset:6144
    v_mfma_f32_16x16x32_bf16 v[244:247], v[224:227], v[252:255], v[244:247]
    ds_read_b64_tr_b16 v[236:237], v10 offset:4096
    v_mfma_f32_16x16x32_bf16 v[248:251], v[228:231], v[252:255], v[248:251]
    ds_read_b64_tr_b16 v[238:239], v10 offset:4608
    s_waitcnt lgkmcnt(12)
    v_mfma_f32_16x16x32_bf16 v[32:35], v[164:167], v[148:151], v[32:35]
    v_mfma_f32_16x16x32_bf16 v[40:43], v[164:167], v[152:155], v[40:43]
    ds_read_b128 v[70:73], v8 offset:2048
    v_mfma_f32_16x16x32_bf16 v[116:119], v[164:167], v[156:159], v[116:119]
    ds_read_b64_tr_b16 v[196:197], v11 offset:12288
    v_mfma_f32_16x16x32_bf16 v[124:127], v[164:167], v[160:163], v[124:127]
    v_mfma_f32_16x16x32_bf16 v[36:39], v[168:171], v[148:151], v[36:39]
    ds_read_b64_tr_b16 v[198:199], v11 offset:12800
    v_mfma_f32_16x16x32_bf16 v[44:47], v[168:171], v[152:155], v[44:47]
    ds_read_b64_tr_b16 v[200:201], v12 offset:12288
    v_mfma_f32_16x16x32_bf16 v[120:123], v[168:171], v[156:159], v[120:123]
    ds_read_b64_tr_b16 v[202:203], v12 offset:12800
    v_mfma_f32_16x16x32_bf16 v[128:131], v[168:171], v[160:163], v[128:131]
    s_waitcnt lgkmcnt(13)
    v_mfma_f32_16x16x32_bf16 v[48:51], v[172:175], v[148:151], v[48:51]
    ds_read_b64_tr_b16 v[204:205], v74 offset:20480
    v_mfma_f32_16x16x32_bf16 v[56:59], v[172:175], v[152:155], v[56:59]
    ds_read_b64_tr_b16 v[206:207], v74 offset:20992
    v_mfma_f32_16x16x32_bf16 v[132:135], v[172:175], v[156:159], v[132:135]
    v_mfma_f32_16x16x32_bf16 v[140:143], v[172:175], v[160:163], v[140:143]
    ds_read_b64_tr_b16 v[240:241], v75 offset:20480
    v_mfma_f32_16x16x32_bf16 v[52:55], v[176:179], v[148:151], v[52:55]
    ds_read_b64_tr_b16 v[242:243], v75 offset:20992
    v_mfma_f32_16x16x32_bf16 v[60:63], v[176:179], v[152:155], v[60:63]
    v_mfma_f32_16x16x32_bf16 v[136:139], v[176:179], v[156:159], v[136:139]
    v_mfma_f32_16x16x32_bf16 v[144:147], v[176:179], v[160:163], v[144:147]
    s_waitcnt lgkmcnt(8)
    v_mfma_f32_16x16x32_bf16 v[16:19], v[232:235], v[180:183], v[16:19]
    s_waitcnt lgkmcnt(0)
    s_barrier
    ds_read_b128 v[148:151], v5 offset:40960
    v_mfma_f32_16x16x32_bf16 v[24:27], v[232:235], v[184:187], v[24:27]
    ds_read_b128 v[152:155], v5 offset:43008
    v_mfma_f32_16x16x32_bf16 v[100:103], v[232:235], v[188:191], v[100:103]
    ds_read_b64_tr_b16 v[224:225], v9 offset:40960
    v_mfma_f32_16x16x32_bf16 v[108:111], v[232:235], v[192:195], v[108:111]
    v_mfma_f32_16x16x32_bf16 v[20:23], v[236:239], v[180:183], v[20:23]
    ds_read_b64_tr_b16 v[226:227], v9 offset:41472
    v_mfma_f32_16x16x32_bf16 v[28:31], v[236:239], v[184:187], v[28:31]
    ds_read_b128 v[156:159], v5 offset:45056
    v_mfma_f32_16x16x32_bf16 v[104:107], v[236:239], v[188:191], v[104:107]
    v_mfma_f32_16x16x32_bf16 v[112:115], v[236:239], v[192:195], v[112:115]
    ds_read_b128 v[160:163], v5 offset:47104
    v_mfma_f32_16x16x32_bf16 v[244:247], v[232:235], v[70:73], v[244:247]
    ds_read_b64_tr_b16 v[228:229], v10 offset:40960
    v_mfma_f32_16x16x32_bf16 v[248:251], v[236:239], v[70:73], v[248:251]
    ds_read_b64_tr_b16 v[230:231], v10 offset:41472
    v_mfma_f32_16x16x32_bf16 v[32:35], v[196:199], v[180:183], v[32:35]
    v_mfma_f32_16x16x32_bf16 v[40:43], v[196:199], v[184:187], v[40:43]
    ds_read_b128 v[252:255], v7 offset:4096
    v_mfma_f32_16x16x32_bf16 v[116:119], v[196:199], v[188:191], v[116:119]
    ds_read_b64_tr_b16 v[164:165], v11 offset:49152
    v_mfma_f32_16x16x32_bf16 v[124:127], v[196:199], v[192:195], v[124:127]
    v_mfma_f32_16x16x32_bf16 v[36:39], v[200:203], v[180:183], v[36:39]
    ds_read_b64_tr_b16 v[166:167], v11 offset:49664
    v_mfma_f32_16x16x32_bf16 v[44:47], v[200:203], v[184:187], v[44:47]
    ds_read_b64_tr_b16 v[168:169], v12 offset:49152
    v_mfma_f32_16x16x32_bf16 v[120:123], v[200:203], v[188:191], v[120:123]
    ds_read_b64_tr_b16 v[170:171], v12 offset:49664
    v_mfma_f32_16x16x32_bf16 v[128:131], v[200:203], v[192:195], v[128:131]
    v_mfma_f32_16x16x32_bf16 v[48:51], v[204:207], v[180:183], v[48:51]
    ds_read_b64_tr_b16 v[172:173], v74 offset:57344
    v_mfma_f32_16x16x32_bf16 v[56:59], v[204:207], v[184:187], v[56:59]
    ds_read_b64_tr_b16 v[174:175], v74 offset:57856
    v_mfma_f32_16x16x32_bf16 v[132:135], v[204:207], v[188:191], v[132:135]
    v_mfma_f32_16x16x32_bf16 v[140:143], v[204:207], v[192:195], v[140:143]
    ds_read_b64_tr_b16 v[176:177], v75 offset:57344
    v_mfma_f32_16x16x32_bf16 v[52:55], v[240:243], v[180:183], v[52:55]
    ds_read_b64_tr_b16 v[178:179], v75 offset:57856
    v_mfma_f32_16x16x32_bf16 v[60:63], v[240:243], v[184:187], v[60:63]
    v_mfma_f32_16x16x32_bf16 v[136:139], v[240:243], v[188:191], v[136:139]
    v_mfma_f32_16x16x32_bf16 v[144:147], v[240:243], v[192:195], v[144:147]
    s_waitcnt lgkmcnt(8)
    v_mfma_f32_16x16x32_bf16 v[16:19], v[224:227], v[148:151], v[16:19]
    ds_read_b128 v[180:183], v6 offset:40960
    v_mfma_f32_16x16x32_bf16 v[24:27], v[224:227], v[152:155], v[24:27]
    ds_read_b128 v[184:187], v6 offset:43008
    v_mfma_f32_16x16x32_bf16 v[100:103], v[224:227], v[156:159], v[100:103]
    ds_read_b64_tr_b16 v[232:233], v9 offset:45056
    v_mfma_f32_16x16x32_bf16 v[108:111], v[224:227], v[160:163], v[108:111]
    v_mfma_f32_16x16x32_bf16 v[20:23], v[228:231], v[148:151], v[20:23]
    ds_read_b64_tr_b16 v[234:235], v9 offset:45568
    v_mfma_f32_16x16x32_bf16 v[28:31], v[228:231], v[152:155], v[28:31]
    ds_read_b128 v[188:191], v6 offset:45056
    v_mfma_f32_16x16x32_bf16 v[104:107], v[228:231], v[156:159], v[104:107]
    v_mfma_f32_16x16x32_bf16 v[112:115], v[228:231], v[160:163], v[112:115]
    ds_read_b128 v[192:195], v6 offset:47104
    v_mfma_f32_16x16x32_bf16 v[244:247], v[224:227], v[252:255], v[244:247]
    ds_read_b64_tr_b16 v[236:237], v10 offset:45056
    v_mfma_f32_16x16x32_bf16 v[248:251], v[228:231], v[252:255], v[248:251]
    ds_read_b64_tr_b16 v[238:239], v10 offset:45568
    s_waitcnt lgkmcnt(12)
    v_mfma_f32_16x16x32_bf16 v[32:35], v[164:167], v[148:151], v[32:35]
    v_mfma_f32_16x16x32_bf16 v[40:43], v[164:167], v[152:155], v[40:43]
    ds_read_b128 v[70:73], v8 offset:4096
    v_mfma_f32_16x16x32_bf16 v[116:119], v[164:167], v[156:159], v[116:119]
    ds_read_b64_tr_b16 v[196:197], v11 offset:53248
    v_mfma_f32_16x16x32_bf16 v[124:127], v[164:167], v[160:163], v[124:127]
    v_mfma_f32_16x16x32_bf16 v[36:39], v[168:171], v[148:151], v[36:39]
L_TB0_0:
    s_cbranch_execz L_TB0_1
    s_nop 0
    ds_read_b64_tr_b16 v[198:199], v11 offset:53760
    v_mfma_f32_16x16x32_bf16 v[44:47], v[168:171], v[152:155], v[44:47]
    ds_read_b64_tr_b16 v[200:201], v12 offset:53248
    v_mfma_f32_16x16x32_bf16 v[120:123], v[168:171], v[156:159], v[120:123]
    ds_read_b64_tr_b16 v[202:203], v12 offset:53760
    v_mfma_f32_16x16x32_bf16 v[128:131], v[168:171], v[160:163], v[128:131]
    s_waitcnt lgkmcnt(13)
    v_mfma_f32_16x16x32_bf16 v[48:51], v[172:175], v[148:151], v[48:51]
    ds_read_b64_tr_b16 v[204:205], v74 offset:61440
    v_mfma_f32_16x16x32_bf16 v[56:59], v[172:175], v[152:155], v[56:59]
    ds_read_b64_tr_b16 v[206:207], v74 offset:61952
    v_mfma_f32_16x16x32_bf16 v[132:135], v[172:175], v[156:159], v[132:135]
    v_mfma_f32_16x16x32_bf16 v[140:143], v[172:175], v[160:163], v[140:143]
    ds_read_b64_tr_b16 v[240:241], v75 offset:61440
    v_mfma_f32_16x16x32_bf16 v[52:55], v[176:179], v[148:151], v[52:55]
    ds_read_b64_tr_b16 v[242:243], v75 offset:61952
    v_mfma_f32_16x16x32_bf16 v[60:63], v[176:179], v[152:155], v[60:63]
    v_mfma_f32_16x16x32_bf16 v[136:139], v[176:179], v[156:159], v[136:139]
    v_mfma_f32_16x16x32_bf16 v[144:147], v[176:179], v[160:163], v[144:147]
    s_waitcnt lgkmcnt(8)
    v_mfma_f32_16x16x32_bf16 v[16:19], v[232:235], v[180:183], v[16:19]
    s_waitcnt lgkmcnt(0)
    s_barrier
    ds_read_b128 v[148:151], v1 offset:0
    v_mfma_f32_16x16x32_bf16 v[24:27], v[232:235], v[184:187], v[24:27]
    ds_read_b128 v[152:155], v1 offset:2048
    v_mfma_f32_16x16x32_bf16 v[100:103], v[232:235], v[188:191], v[100:103]
    ds_read_b64_tr_b16 v[224:225], v3 offset:0
    v_mfma_f32_16x16x32_bf16 v[108:111], v[232:235], v[192:195], v[108:111]
    v_mfma_f32_16x16x32_bf16 v[20:23], v[236:239], v[180:183], v[20:23]
    ds_read_b64_tr_b16 v[226:227], v3 offset:512
    v_mfma_f32_16x16x32_bf16 v[28:31], v[236:239], v[184:187], v[28:31]
    ds_read_b128 v[156:159], v1 offset:4096
    v_mfma_f32_16x16x32_bf16 v[104:107], v[236:239], v[188:191], v[104:107]
    v_mfma_f32_16x16x32_bf16 v[112:115], v[236:239], v[192:195], v[112:115]
    ds_read_b128 v[160:163], v1 offset:6144
    v_mfma_f32_16x16x32_bf16 v[244:247], v[232:235], v[70:73], v[244:247]
    ds_read_b64_tr_b16 v[228:229], v64 offset:0
    v_mfma_f32_16x16x32_bf16 v[248:251], v[236:239], v[70:73], v[248:251]
    ds_read_b64_tr_b16 v[230:231], v64 offset:512
    v_mfma_f32_16x16x32_bf16 v[32:35], v[196:199], v[180:183], v[32:35]
    v_mfma_f32_16x16x32_bf16 v[40:43], v[196:199], v[184:187], v[40:43]
    ds_read_b128 v[252:255], v7 offset:6144
    v_mfma_f32_16x16x32_bf16 v[116:119], v[196:199], v[188:191], v[116:119]
    ds_read_b64_tr_b16 v[164:165], v65 offset:8192
    v_mfma_f32_16x16x32_bf16 v[124:127], v[196:199], v[192:195], v[124:127]
    v_mfma_f32_16x16x32_bf16 v[36:39], v[200:203], v[180:183], v[36:39]
    ds_read_b64_tr_b16 v[166:167], v65 offset:8704
    v_mfma_f32_16x16x32_bf16 v[44:47], v[200:203], v[184:187], v[44:47]
    ds_read_b64_tr_b16 v[168:169], v66 offset:8192
    v_mfma_f32_16x16x32_bf16 v[120:123], v[200:203], v[188:191], v[120:123]
    ds_read_b64_tr_b16 v[170:171], v66 offset:8704
    v_mfma_f32_16x16x32_bf16 v[128:131], v[200:203], v[192:195], v[128:131]
    v_mfma_f32_16x16x32_bf16 v[48:51], v[204:207], v[180:183], v[48:51]
    ds_read_b64_tr_b16 v[172:173], v67 offset:16384
    v_mfma_f32_16x16x32_bf16 v[56:59], v[204:207], v[184:187], v[56:59]
    ds_read_b64_tr_b16 v[174:175], v67 offset:16896
    v_mfma_f32_16x16x32_bf16 v[132:135], v[204:207], v[188:191], v[132:135]
    v_mfma_f32_16x16x32_bf16 v[140:143], v[204:207], v[192:195], v[140:143]
    ds_read_b64_tr_b16 v[176:177], v69 offset:16384
    v_mfma_f32_16x16x32_bf16 v[52:55], v[240:243], v[180:183], v[52:55]
    ds_read_b64_tr_b16 v[178:179], v69 offset:16896
    v_mfma_f32_16x16x32_bf16 v[60:63], v[240:243], v[184:187], v[60:63]
    v_mfma_f32_16x16x32_bf16 v[136:139], v[240:243], v[188:191], v[136:139]
    v_mfma_f32_16x16x32_bf16 v[144:147], v[240:243], v[192:195], v[144:147]
    s_waitcnt lgkmcnt(8)
    v_mfma_f32_16x16x32_bf16 v[16:19], v[224:227], v[148:151], v[16:19]
    ds_read_b128 v[180:183], v2 offset:0
    v_mfma_f32_16x16x32_bf16 v[24:27], v[224:227], v[152:155], v[24:27]
    ds_read_b128 v[184:187], v2 offset:2048
    v_mfma_f32_16x16x32_bf16 v[100:103], v[224:227], v[156:159], v[100:103]
    ds_read_b64_tr_b16 v[232:233], v3 offset:4096
    v_mfma_f32_16x16x32_bf16 v[108:111], v[224:227], v[160:163], v[108:111]
    v_mfma_f32_16x16x32_bf16 v[20:23], v[228:231], v[148:151], v[20:23]
    ds_read_b64_tr_b16 v[234:235], v3 offset:4608
    v_mfma_f32_16x16x32_bf16 v[28:31], v[228:231], v[152:155], v[28:31]
    ds_read_b128 v[188:191], v2 offset:4096
    v_mfma_f32_16x16x32_bf16 v[104:107], v[228:231], v[156:159], v[104:107]
    v_mfma_f32_16x16x32_bf16 v[112:115], v[228:231], v[160:163], v[112:115]
    ds_read_b128 v[192:195], v2 offset:6144
    v_mfma_f32_16x16x32_bf16 v[244:247], v[224:227], v[252:255], v[244:247]
    ds_read_b64_tr_b16 v[236:237], v64 offset:4096
    v_mfma_f32_16x16x32_bf16 v[248:251], v[228:231], v[252:255], v[248:251]
    ds_read_b64_tr_b16 v[238:239], v64 offset:4608
    s_waitcnt lgkmcnt(12)
    v_mfma_f32_16x16x32_bf16 v[32:35], v[164:167], v[148:151], v[32:35]
    v_mfma_f32_16x16x32_bf16 v[40:43], v[164:167], v[152:155], v[40:43]
    ds_read_b128 v[70:73], v8 offset:6144
    v_mfma_f32_16x16x32_bf16 v[116:119], v[164:167], v[156:159], v[116:119]
    ds_read_b64_tr_b16 v[196:197], v65 offset:12288
    v_mfma_f32_16x16x32_bf16 v[124:127], v[164:167], v[160:163], v[124:127]
    v_mfma_f32_16x16x32_bf16 v[36:39], v[168:171], v[148:151], v[36:39]
    ds_read_b64_tr_b16 v[198:199], v65 offset:12800
    v_mfma_f32_16x16x32_bf16 v[44:47], v[168:171], v[152:155], v[44:47]
    ds_read_b64_tr_b16 v[200:201], v66 offset:12288
    v_mfma_f32_16x16x32_bf16 v[120:123], v[168:171], v[156:159], v[120:123]
    ds_read_b64_tr_b16 v[202:203], v66 offset:12800
    v_mfma_f32_16x16x32_bf16 v[128:131], v[168:171], v[160:163], v[128:131]
    s_waitcnt lgkmcnt(13)
    v_mfma_f32_16x16x32_bf16 v[48:51], v[172:175], v[148:151], v[48:51]
    ds_read_b64_tr_b16 v[204:205], v67 offset:20480
    v_mfma_f32_16x16x32_bf16 v[56:59], v[172:175], v[152:155], v[56:59]
    ds_read_b64_tr_b16 v[206:207], v67 offset:20992
    v_mfma_f32_16x16x32_bf16 v[132:135], v[172:175], v[156:159], v[132:135]
    v_mfma_f32_16x16x32_bf16 v[140:143], v[172:175], v[160:163], v[140:143]
    ds_read_b64_tr_b16 v[240:241], v69 offset:20480
    v_mfma_f32_16x16x32_bf16 v[52:55], v[176:179], v[148:151], v[52:55]
    ds_read_b64_tr_b16 v[242:243], v69 offset:20992
    v_mfma_f32_16x16x32_bf16 v[60:63], v[176:179], v[152:155], v[60:63]
    v_mfma_f32_16x16x32_bf16 v[136:139], v[176:179], v[156:159], v[136:139]
    v_mfma_f32_16x16x32_bf16 v[144:147], v[176:179], v[160:163], v[144:147]
    s_waitcnt lgkmcnt(8)
    v_mfma_f32_16x16x32_bf16 v[16:19], v[232:235], v[180:183], v[16:19]
    s_waitcnt lgkmcnt(0)
    s_barrier
    ds_read_b128 v[148:151], v5 offset:0
    v_mfma_f32_16x16x32_bf16 v[24:27], v[232:235], v[184:187], v[24:27]
    ds_read_b128 v[152:155], v5 offset:2048
    v_mfma_f32_16x16x32_bf16 v[100:103], v[232:235], v[188:191], v[100:103]
    ds_read_b64_tr_b16 v[224:225], v9 offset:0
    v_mfma_f32_16x16x32_bf16 v[108:111], v[232:235], v[192:195], v[108:111]
    v_mfma_f32_16x16x32_bf16 v[20:23], v[236:239], v[180:183], v[20:23]
    ds_read_b64_tr_b16 v[226:227], v9 offset:512
    v_mfma_f32_16x16x32_bf16 v[28:31], v[236:239], v[184:187], v[28:31]
    ds_read_b128 v[156:159], v5 offset:4096
    v_mfma_f32_16x16x32_bf16 v[104:107], v[236:239], v[188:191], v[104:107]
    v_mfma_f32_16x16x32_bf16 v[112:115], v[236:239], v[192:195], v[112:115]
    ds_read_b128 v[160:163], v5 offset:6144
    v_mfma_f32_16x16x32_bf16 v[244:247], v[232:235], v[70:73], v[244:247]
    ds_read_b64_tr_b16 v[228:229], v10 offset:0
    v_mfma_f32_16x16x32_bf16 v[248:251], v[236:239], v[70:73], v[248:251]
    ds_read_b64_tr_b16 v[230:231], v10 offset:512
    v_mfma_f32_16x16x32_bf16 v[32:35], v[196:199], v[180:183], v[32:35]
    v_mfma_f32_16x16x32_bf16 v[40:43], v[196:199], v[184:187], v[40:43]
    ds_read_b128 v[252:255], v7 offset:8192
    v_mfma_f32_16x16x32_bf16 v[116:119], v[196:199], v[188:191], v[116:119]
    ds_read_b64_tr_b16 v[164:165], v11 offset:8192
    v_mfma_f32_16x16x32_bf16 v[124:127], v[196:199], v[192:195], v[124:127]
    v_mfma_f32_16x16x32_bf16 v[36:39], v[200:203], v[180:183], v[36:39]
    ds_read_b64_tr_b16 v[166:167], v11 offset:8704
    v_mfma_f32_16x16x32_bf16 v[44:47], v[200:203], v[184:187], v[44:47]
    ds_read_b64_tr_b16 v[168:169], v12 offset:8192
    v_mfma_f32_16x16x32_bf16 v[120:123], v[200:203], v[188:191], v[120:123]
    ds_read_b64_tr_b16 v[170:171], v12 offset:8704
    v_mfma_f32_16x16x32_bf16 v[128:131], v[200:203], v[192:195], v[128:131]
    v_mfma_f32_16x16x32_bf16 v[48:51], v[204:207], v[180:183], v[48:51]
    ds_read_b64_tr_b16 v[172:173], v74 offset:16384
    v_mfma_f32_16x16x32_bf16 v[56:59], v[204:207], v[184:187], v[56:59]
    ds_read_b64_tr_b16 v[174:175], v74 offset:16896
    v_mfma_f32_16x16x32_bf16 v[132:135], v[204:207], v[188:191], v[132:135]
    v_mfma_f32_16x16x32_bf16 v[140:143], v[204:207], v[192:195], v[140:143]
    ds_read_b64_tr_b16 v[176:177], v75 offset:16384
    v_mfma_f32_16x16x32_bf16 v[52:55], v[240:243], v[180:183], v[52:55]
    ds_read_b64_tr_b16 v[178:179], v75 offset:16896
    v_mfma_f32_16x16x32_bf16 v[60:63], v[240:243], v[184:187], v[60:63]
    v_mfma_f32_16x16x32_bf16 v[136:139], v[240:243], v[188:191], v[136:139]
    v_mfma_f32_16x16x32_bf16 v[144:147], v[240:243], v[192:195], v[144:147]
    s_waitcnt lgkmcnt(8)
    v_mfma_f32_16x16x32_bf16 v[16:19], v[224:227], v[148:151], v[16:19]
    ds_read_b128 v[180:183], v6 offset:0
    v_mfma_f32_16x16x32_bf16 v[24:27], v[224:227], v[152:155], v[24:27]
    ds_read_b128 v[184:187], v6 offset:2048
    v_mfma_f32_16x16x32_bf16 v[100:103], v[224:227], v[156:159], v[100:103]
    ds_read_b64_tr_b16 v[232:233], v9 offset:4096
    v_mfma_f32_16x16x32_bf16 v[108:111], v[224:227], v[160:163], v[108:111]
    v_mfma_f32_16x16x32_bf16 v[20:23], v[228:231], v[148:151], v[20:23]
    ds_read_b64_tr_b16 v[234:235], v9 offset:4608
    v_mfma_f32_16x16x32_bf16 v[28:31], v[228:231], v[152:155], v[28:31]
    ds_read_b128 v[188:191], v6 offset:4096
    v_mfma_f32_16x16x32_bf16 v[104:107], v[228:231], v[156:159], v[104:107]
    v_mfma_f32_16x16x32_bf16 v[112:115], v[228:231], v[160:163], v[112:115]
    ds_read_b128 v[192:195], v6 offset:6144
    v_mfma_f32_16x16x32_bf16 v[244:247], v[224:227], v[252:255], v[244:247]
    ds_read_b64_tr_b16 v[236:237], v10 offset:4096
    v_mfma_f32_16x16x32_bf16 v[248:251], v[228:231], v[252:255], v[248:251]
    ds_read_b64_tr_b16 v[238:239], v10 offset:4608
    s_waitcnt lgkmcnt(12)
    v_mfma_f32_16x16x32_bf16 v[32:35], v[164:167], v[148:151], v[32:35]
    v_mfma_f32_16x16x32_bf16 v[40:43], v[164:167], v[152:155], v[40:43]
    ds_read_b128 v[70:73], v8 offset:8192
    v_mfma_f32_16x16x32_bf16 v[116:119], v[164:167], v[156:159], v[116:119]
    ds_read_b64_tr_b16 v[196:197], v11 offset:12288
    v_mfma_f32_16x16x32_bf16 v[124:127], v[164:167], v[160:163], v[124:127]
    v_mfma_f32_16x16x32_bf16 v[36:39], v[168:171], v[148:151], v[36:39]
    ds_read_b64_tr_b16 v[198:199], v11 offset:12800
    v_mfma_f32_16x16x32_bf16 v[44:47], v[168:171], v[152:155], v[44:47]
    ds_read_b64_tr_b16 v[200:201], v12 offset:12288
    v_mfma_f32_16x16x32_bf16 v[120:123], v[168:171], v[156:159], v[120:123]
    ds_read_b64_tr_b16 v[202:203], v12 offset:12800
    v_mfma_f32_16x16x32_bf16 v[128:131], v[168:171], v[160:163], v[128:131]
    s_waitcnt lgkmcnt(13)
    v_mfma_f32_16x16x32_bf16 v[48:51], v[172:175], v[148:151], v[48:51]
    ds_read_b64_tr_b16 v[204:205], v74 offset:20480
    v_mfma_f32_16x16x32_bf16 v[56:59], v[172:175], v[152:155], v[56:59]
    ds_read_b64_tr_b16 v[206:207], v74 offset:20992
    v_mfma_f32_16x16x32_bf16 v[132:135], v[172:175], v[156:159], v[132:135]
    v_mfma_f32_16x16x32_bf16 v[140:143], v[172:175], v[160:163], v[140:143]
    ds_read_b64_tr_b16 v[240:241], v75 offset:20480
    v_mfma_f32_16x16x32_bf16 v[52:55], v[176:179], v[148:151], v[52:55]
    ds_read_b64_tr_b16 v[242:243], v75 offset:20992
    v_mfma_f32_16x16x32_bf16 v[60:63], v[176:179], v[152:155], v[60:63]
    v_mfma_f32_16x16x32_bf16 v[136:139], v[176:179], v[156:159], v[136:139]
    v_mfma_f32_16x16x32_bf16 v[144:147], v[176:179], v[160:163], v[144:147]
    buffer_load_dwordx2 v[14:15], off, s[36:39], 0 sc1
    s_waitcnt lgkmcnt(8)
    v_mfma_f32_16x16x32_bf16 v[16:19], v[232:235], v[180:183], v[16:19]
    s_waitcnt lgkmcnt(0)
    s_barrier
    ds_read_b128 v[148:151], v5 offset:40960
    v_mfma_f32_16x16x32_bf16 v[24:27], v[232:235], v[184:187], v[24:27]
    ds_read_b128 v[152:155], v5 offset:43008
    v_mfma_f32_16x16x32_bf16 v[100:103], v[232:235], v[188:191], v[100:103]
    ds_read_b64_tr_b16 v[224:225], v9 offset:40960
    v_mfma_f32_16x16x32_bf16 v[108:111], v[232:235], v[192:195], v[108:111]
    v_mfma_f32_16x16x32_bf16 v[20:23], v[236:239], v[180:183], v[20:23]
    ds_read_b64_tr_b16 v[226:227], v9 offset:41472
    v_mfma_f32_16x16x32_bf16 v[28:31], v[236:239], v[184:187], v[28:31]
    ds_read_b128 v[156:159], v5 offset:45056
    v_mfma_f32_16x16x32_bf16 v[104:107], v[236:239], v[188:191], v[104:107]
    v_mfma_f32_16x16x32_bf16 v[112:115], v[236:239], v[192:195], v[112:115]
    ds_read_b128 v[160:163], v5 offset:47104
    v_mfma_f32_16x16x32_bf16 v[244:247], v[232:235], v[70:73], v[244:247]
    ds_read_b64_tr_b16 v[228:229], v10 offset:40960
    v_mfma_f32_16x16x32_bf16 v[248:251], v[236:239], v[70:73], v[248:251]
    ds_read_b64_tr_b16 v[230:231], v10 offset:41472
    v_mfma_f32_16x16x32_bf16 v[32:35], v[196:199], v[180:183], v[32:35]
    v_mfma_f32_16x16x32_bf16 v[40:43], v[196:199], v[184:187], v[40:43]
    ds_read_b128 v[252:255], v7 offset:10240
    v_mfma_f32_16x16x32_bf16 v[116:119], v[196:199], v[188:191], v[116:119]
    ds_read_b64_tr_b16 v[164:165], v11 offset:49152
    v_mfma_f32_16x16x32_bf16 v[124:127], v[196:199], v[192:195], v[124:127]
    v_mfma_f32_16x16x32_bf16 v[36:39], v[200:203], v[180:183], v[36:39]
    ds_read_b64_tr_b16 v[166:167], v11 offset:49664
    v_mfma_f32_16x16x32_bf16 v[44:47], v[200:203], v[184:187], v[44:47]
    ds_read_b64_tr_b16 v[168:169], v12 offset:49152
    v_mfma_f32_16x16x32_bf16 v[120:123], v[200:203], v[188:191], v[120:123]
    ds_read_b64_tr_b16 v[170:171], v12 offset:49664
    v_mfma_f32_16x16x32_bf16 v[128:131], v[200:203], v[192:195], v[128:131]
    v_mfma_f32_16x16x32_bf16 v[48:51], v[204:207], v[180:183], v[48:51]
    ds_read_b64_tr_b16 v[172:173], v74 offset:57344
    v_mfma_f32_16x16x32_bf16 v[56:59], v[204:207], v[184:187], v[56:59]
    ds_read_b64_tr_b16 v[174:175], v74 offset:57856
    v_mfma_f32_16x16x32_bf16 v[132:135], v[204:207], v[188:191], v[132:135]
    v_mfma_f32_16x16x32_bf16 v[140:143], v[204:207], v[192:195], v[140:143]
    ds_read_b64_tr_b16 v[176:177], v75 offset:57344
    v_mfma_f32_16x16x32_bf16 v[52:55], v[240:243], v[180:183], v[52:55]
    ds_read_b64_tr_b16 v[178:179], v75 offset:57856
    v_mfma_f32_16x16x32_bf16 v[60:63], v[240:243], v[184:187], v[60:63]
    v_mfma_f32_16x16x32_bf16 v[136:139], v[240:243], v[188:191], v[136:139]
    v_mfma_f32_16x16x32_bf16 v[144:147], v[240:243], v[192:195], v[144:147]
    s_waitcnt lgkmcnt(8)
    v_mfma_f32_16x16x32_bf16 v[16:19], v[224:227], v[148:151], v[16:19]
    ds_read_b128 v[180:183], v6 offset:40960
    v_mfma_f32_16x16x32_bf16 v[24:27], v[224:227], v[152:155], v[24:27]
    ds_read_b128 v[184:187], v6 offset:43008
    v_mfma_f32_16x16x32_bf16 v[100:103], v[224:227], v[156:159], v[100:103]
    ds_read_b64_tr_b16 v[232:233], v9 offset:45056
    v_mfma_f32_16x16x32_bf16 v[108:111], v[224:227], v[160:163], v[108:111]
    v_mfma_f32_16x16x32_bf16 v[20:23], v[228:231], v[148:151], v[20:23]
    ds_read_b64_tr_b16 v[234:235], v9 offset:45568
    v_mfma_f32_16x16x32_bf16 v[28:31], v[228:231], v[152:155], v[28:31]
    ds_read_b128 v[188:191], v6 offset:45056
    v_mfma_f32_16x16x32_bf16 v[104:107], v[228:231], v[156:159], v[104:107]
    v_mfma_f32_16x16x32_bf16 v[112:115], v[228:231], v[160:163], v[112:115]
    ds_read_b128 v[192:195], v6 offset:47104
    v_mfma_f32_16x16x32_bf16 v[244:247], v[224:227], v[252:255], v[244:247]
    ds_read_b64_tr_b16 v[236:237], v10 offset:45056
    v_mfma_f32_16x16x32_bf16 v[248:251], v[228:231], v[252:255], v[248:251]
    ds_read_b64_tr_b16 v[238:239], v10 offset:45568
    s_waitcnt lgkmcnt(12)
    v_mfma_f32_16x16x32_bf16 v[32:35], v[164:167], v[148:151], v[32:35]
    v_mfma_f32_16x16x32_bf16 v[40:43], v[164:167], v[152:155], v[40:43]
    ds_read_b128 v[70:73], v8 offset:10240
    v_mfma_f32_16x16x32_bf16 v[116:119], v[164:167], v[156:159], v[116:119]
    ds_read_b64_tr_b16 v[196:197], v11 offset:53248
    v_mfma_f32_16x16x32_bf16 v[124:127], v[164:167], v[160:163], v[124:127]
    v_mfma_f32_16x16x32_bf16 v[36:39], v[168:171], v[148:151], v[36:39]
    ds_read_b64_tr_b16 v[198:199], v11 offset:53760
    v_mfma_f32_16x16x32_bf16 v[44:47], v[168:171], v[152:155], v[44:47]
    ds_read_b64_tr_b16 v[200:201], v12 offset:53248
    v_mfma_f32_16x16x32_bf16 v[120:123], v[168:171], v[156:159], v[120:123]
    ds_read_b64_tr_b16 v[202:203], v12 offset:53760
    v_mfma_f32_16x16x32_bf16 v[128:131], v[168:171], v[160:163], v[128:131]
    s_waitcnt lgkmcnt(13)
    v_mfma_f32_16x16x32_bf16 v[48:51], v[172:175], v[148:151], v[48:51]
    ds_read_b64_tr_b16 v[204:205], v74 offset:61440
    v_mfma_f32_16x16x32_bf16 v[56:59], v[172:175], v[152:155], v[56:59]
    ds_read_b64_tr_b16 v[206:207], v74 offset:61952
    v_mfma_f32_16x16x32_bf16 v[132:135], v[172:175], v[156:159], v[132:135]
    v_mfma_f32_16x16x32_bf16 v[140:143], v[172:175], v[160:163], v[140:143]
    ds_read_b64_tr_b16 v[240:241], v75 offset:61440
    v_mfma_f32_16x16x32_bf16 v[52:55], v[176:179], v[148:151], v[52:55]
    ds_read_b64_tr_b16 v[242:243], v75 offset:61952
    v_mfma_f32_16x16x32_bf16 v[60:63], v[176:179], v[152:155], v[60:63]
    v_mfma_f32_16x16x32_bf16 v[136:139], v[176:179], v[156:159], v[136:139]
    v_mfma_f32_16x16x32_bf16 v[144:147], v[176:179], v[160:163], v[144:147]
    s_waitcnt lgkmcnt(8)
    v_mfma_f32_16x16x32_bf16 v[16:19], v[232:235], v[180:183], v[16:19]
    s_waitcnt lgkmcnt(0)
    s_barrier
    ds_read_b128 v[148:151], v1 offset:0
    v_mfma_f32_16x16x32_bf16 v[24:27], v[232:235], v[184:187], v[24:27]
    ds_read_b128 v[152:155], v1 offset:2048
    v_mfma_f32_16x16x32_bf16 v[100:103], v[232:235], v[188:191], v[100:103]
    ds_read_b64_tr_b16 v[224:225], v3 offset:0
    v_mfma_f32_16x16x32_bf16 v[108:111], v[232:235], v[192:195], v[108:111]
    v_mfma_f32_16x16x32_bf16 v[20:23], v[236:239], v[180:183], v[20:23]
    ds_read_b64_tr_b16 v[226:227], v3 offset:512
    v_mfma_f32_16x16x32_bf16 v[28:31], v[236:239], v[184:187], v[28:31]
    ds_read_b128 v[156:159], v1 offset:4096
    v_mfma_f32_16x16x32_bf16 v[104:107], v[236:239], v[188:191], v[104:107]
    v_mfma_f32_16x16x32_bf16 v[112:115], v[236:239], v[192:195], v[112:115]
    ds_read_b128 v[160:163], v1 offset:6144
    v_mfma_f32_16x16x32_bf16 v[244:247], v[232:235], v[70:73], v[244:247]
    ds_read_b64_tr_b16 v[228:229], v64 offset:0
    v_mfma_f32_16x16x32_bf16 v[248:251], v[236:239], v[70:73], v[248:251]
    ds_read_b64_tr_b16 v[230:231], v64 offset:512
    v_mfma_f32_16x16x32_bf16 v[32:35], v[196:199], v[180:183], v[32:35]
    v_mfma_f32_16x16x32_bf16 v[40:43], v[196:199], v[184:187], v[40:43]
    ds_read_b128 v[252:255], v7 offset:12288
    v_mfma_f32_16x16x32_bf16 v[116:119], v[196:199], v[188:191], v[116:119]
    ds_read_b64_tr_b16 v[164:165], v65 offset:8192
    v_mfma_f32_16x16x32_bf16 v[124:127], v[196:199], v[192:195], v[124:127]
    v_mfma_f32_16x16x32_bf16 v[36:39], v[200:203], v[180:183], v[36:39]
    ds_read_b64_tr_b16 v[166:167], v65 offset:8704
    v_mfma_f32_16x16x32_bf16 v[44:47], v[200:203], v[184:187], v[44:47]
    ds_read_b64_tr_b16 v[168:169], v66 offset:8192
    v_mfma_f32_16x16x32_bf16 v[120:123], v[200:203], v[188:191], v[120:123]
    ds_read_b64_tr_b16 v[170:171], v66 offset:8704
    v_mfma_f32_16x16x32_bf16 v[128:131], v[200:203], v[192:195], v[128:131]
    v_mfma_f32_16x16x32_bf16 v[48:51], v[204:207], v[180:183], v[48:51]
    ds_read_b64_tr_b16 v[172:173], v67 offset:16384
    v_mfma_f32_16x16x32_bf16 v[56:59], v[204:207], v[184:187], v[56:59]
    ds_read_b64_tr_b16 v[174:175], v67 offset:16896
    v_mfma_f32_16x16x32_bf16 v[132:135], v[204:207], v[188:191], v[132:135]
    v_mfma_f32_16x16x32_bf16 v[140:143], v[204:207], v[192:195], v[140:143]
    ds_read_b64_tr_b16 v[176:177], v69 offset:16384
    v_mfma_f32_16x16x32_bf16 v[52:55], v[240:243], v[180:183], v[52:55]
    ds_read_b64_tr_b16 v[178:179], v69 offset:16896
    v_mfma_f32_16x16x32_bf16 v[60:63], v[240:243], v[184:187], v[60:63]
    v_mfma_f32_16x16x32_bf16 v[136:139], v[240:243], v[188:191], v[136:139]
    v_mfma_f32_16x16x32_bf16 v[144:147], v[240:243], v[192:195], v[144:147]
    s_waitcnt lgkmcnt(8)
    v_mfma_f32_16x16x32_bf16 v[16:19], v[224:227], v[148:151], v[16:19]
    ds_read_b128 v[180:183], v2 offset:0
    v_mfma_f32_16x16x32_bf16 v[24:27], v[224:227], v[152:155], v[24:27]
    ds_read_b128 v[184:187], v2 offset:2048
    v_mfma_f32_16x16x32_bf16 v[100:103], v[224:227], v[156:159], v[100:103]
    ds_read_b64_tr_b16 v[232:233], v3 offset:4096
    v_mfma_f32_16x16x32_bf16 v[108:111], v[224:227], v[160:163], v[108:111]
    v_mfma_f32_16x16x32_bf16 v[20:23], v[228:231], v[148:151], v[20:23]
    ds_read_b64_tr_b16 v[234:235], v3 offset:4608
    v_mfma_f32_16x16x32_bf16 v[28:31], v[228:231], v[152:155], v[28:31]
    ds_read_b128 v[188:191], v2 offset:4096
    v_mfma_f32_16x16x32_bf16 v[104:107], v[228:231], v[156:159], v[104:107]
    v_mfma_f32_16x16x32_bf16 v[112:115], v[228:231], v[160:163], v[112:115]
    ds_read_b128 v[192:195], v2 offset:6144
    v_mfma_f32_16x16x32_bf16 v[244:247], v[224:227], v[252:255], v[244:247]
    ds_read_b64_tr_b16 v[236:237], v64 offset:4096
    v_mfma_f32_16x16x32_bf16 v[248:251], v[228:231], v[252:255], v[248:251]
    ds_read_b64_tr_b16 v[238:239], v64 offset:4608
    s_waitcnt lgkmcnt(12)
    v_mfma_f32_16x16x32_bf16 v[32:35], v[164:167], v[148:151], v[32:35]
    v_mfma_f32_16x16x32_bf16 v[40:43], v[164:167], v[152:155], v[40:43]
    ds_read_b128 v[70:73], v8 offset:12288
    v_mfma_f32_16x16x32_bf16 v[116:119], v[164:167], v[156:159], v[116:119]
    ds_read_b64_tr_b16 v[196:197], v65 offset:12288
    v_mfma_f32_16x16x32_bf16 v[124:127], v[164:167], v[160:163], v[124:127]
    v_mfma_f32_16x16x32_bf16 v[36:39], v[168:171], v[148:151], v[36:39]
    ds_read_b64_tr_b16 v[198:199], v65 offset:12800
    v_mfma_f32_16x16x32_bf16 v[44:47], v[168:171], v[152:155], v[44:47]
    ds_read_b64_tr_b16 v[200:201], v66 offset:12288
    v_mfma_f32_16x16x32_bf16 v[120:123], v[168:171], v[156:159], v[120:123]
    ds_read_b64_tr_b16 v[202:203], v66 offset:12800
    v_mfma_f32_16x16x32_bf16 v[128:131], v[168:171], v[160:163], v[128:131]
    s_waitcnt lgkmcnt(13)
    v_mfma_f32_16x16x32_bf16 v[48:51], v[172:175], v[148:151], v[48:51]
    ds_read_b64_tr_b16 v[204:205], v67 offset:20480
    v_mfma_f32_16x16x32_bf16 v[56:59], v[172:175], v[152:155], v[56:59]
    ds_read_b64_tr_b16 v[206:207], v67 offset:20992
    v_mfma_f32_16x16x32_bf16 v[132:135], v[172:175], v[156:159], v[132:135]
    v_mfma_f32_16x16x32_bf16 v[140:143], v[172:175], v[160:163], v[140:143]
    ds_read_b64_tr_b16 v[240:241], v69 offset:20480
    v_mfma_f32_16x16x32_bf16 v[52:55], v[176:179], v[148:151], v[52:55]
    ds_read_b64_tr_b16 v[242:243], v69 offset:20992
    v_mfma_f32_16x16x32_bf16 v[60:63], v[176:179], v[152:155], v[60:63]
    v_mfma_f32_16x16x32_bf16 v[136:139], v[176:179], v[156:159], v[136:139]
    v_mfma_f32_16x16x32_bf16 v[144:147], v[176:179], v[160:163], v[144:147]
    s_waitcnt lgkmcnt(8)
    v_mfma_f32_16x16x32_bf16 v[16:19], v[232:235], v[180:183], v[16:19]
    s_waitcnt lgkmcnt(0)
    s_barrier
    ds_read_b128 v[148:151], v5 offset:0
    v_mfma_f32_16x16x32_bf16 v[24:27], v[232:235], v[184:187], v[24:27]
    ds_read_b128 v[152:155], v5 offset:2048
    v_mfma_f32_16x16x32_bf16 v[100:103], v[232:235], v[188:191], v[100:103]
    ds_read_b64_tr_b16 v[224:225], v9 offset:0
    v_mfma_f32_16x16x32_bf16 v[108:111], v[232:235], v[192:195], v[108:111]
    v_mfma_f32_16x16x32_bf16 v[20:23], v[236:239], v[180:183], v[20:23]
    ds_read_b64_tr_b16 v[226:227], v9 offset:512
    v_mfma_f32_16x16x32_bf16 v[28:31], v[236:239], v[184:187], v[28:31]
    ds_read_b128 v[156:159], v5 offset:4096
    v_mfma_f32_16x16x32_bf16 v[104:107], v[236:239], v[188:191], v[104:107]
    v_mfma_f32_16x16x32_bf16 v[112:115], v[236:239], v[192:195], v[112:115]
    ds_read_b128 v[160:163], v5 offset:6144
    v_mfma_f32_16x16x32_bf16 v[244:247], v[232:235], v[70:73], v[244:247]
    ds_read_b64_tr_b16 v[228:229], v10 offset:0
    v_mfma_f32_16x16x32_bf16 v[248:251], v[236:239], v[70:73], v[248:251]
    ds_read_b64_tr_b16 v[230:231], v10 offset:512
    v_mfma_f32_16x16x32_bf16 v[32:35], v[196:199], v[180:183], v[32:35]
    v_mfma_f32_16x16x32_bf16 v[40:43], v[196:199], v[184:187], v[40:43]
    ds_read_b128 v[252:255], v7 offset:14336
    v_mfma_f32_16x16x32_bf16 v[116:119], v[196:199], v[188:191], v[116:119]
    ds_read_b64_tr_b16 v[164:165], v11 offset:8192
    v_mfma_f32_16x16x32_bf16 v[124:127], v[196:199], v[192:195], v[124:127]
    v_mfma_f32_16x16x32_bf16 v[36:39], v[200:203], v[180:183], v[36:39]
    ds_read_b64_tr_b16 v[166:167], v11 offset:8704
    v_mfma_f32_16x16x32_bf16 v[44:47], v[200:203], v[184:187], v[44:47]
    ds_read_b64_tr_b16 v[168:169], v12 offset:8192
    v_mfma_f32_16x16x32_bf16 v[120:123], v[200:203], v[188:191], v[120:123]
    ds_read_b64_tr_b16 v[170:171], v12 offset:8704
    v_mfma_f32_16x16x32_bf16 v[128:131], v[200:203], v[192:195], v[128:131]
    v_mfma_f32_16x16x32_bf16 v[48:51], v[204:207], v[180:183], v[48:51]
    ds_read_b64_tr_b16 v[172:173], v74 offset:16384
    v_mfma_f32_16x16x32_bf16 v[56:59], v[204:207], v[184:187], v[56:59]
    ds_read_b64_tr_b16 v[174:175], v74 offset:16896
    v_mfma_f32_16x16x32_bf16 v[132:135], v[204:207], v[188:191], v[132:135]
    v_mfma_f32_16x16x32_bf16 v[140:143], v[204:207], v[192:195], v[140:143]
    ds_read_b64_tr_b16 v[176:177], v75 offset:16384
    v_mfma_f32_16x16x32_bf16 v[52:55], v[240:243], v[180:183], v[52:55]
    ds_read_b64_tr_b16 v[178:179], v75 offset:16896
    v_mfma_f32_16x16x32_bf16 v[60:63], v[240:243], v[184:187], v[60:63]
    v_mfma_f32_16x16x32_bf16 v[136:139], v[240:243], v[188:191], v[136:139]
    v_mfma_f32_16x16x32_bf16 v[144:147], v[240:243], v[192:195], v[144:147]
    s_waitcnt lgkmcnt(8)
    v_mfma_f32_16x16x32_bf16 v[16:19], v[224:227], v[148:151], v[16:19]
    ds_read_b128 v[180:183], v6 offset:0
    ds_read_b128 v[184:187], v6 offset:2048
    v_mfma_f32_16x16x32_bf16 v[24:27], v[224:227], v[152:155], v[24:27]
    ds_read_b64_tr_b16 v[232:233], v9 offset:4096
    ds_read_b64_tr_b16 v[234:235], v9 offset:4608
    v_mfma_f32_16x16x32_bf16 v[100:103], v[224:227], v[156:159], v[100:103]
    ds_read_b128 v[188:191], v6 offset:4096
    ds_read_b128 v[192:195], v6 offset:6144
    v_mfma_f32_16x16x32_bf16 v[108:111], v[224:227], v[160:163], v[108:111]
    ds_read_b64_tr_b16 v[236:237], v10 offset:4096
    v_mfma_f32_16x16x32_bf16 v[20:23], v[228:231], v[148:151], v[20:23]
    ds_read_b64_tr_b16 v[238:239], v10 offset:4608
    ds_read_b128 v[70:73], v8 offset:14336
    v_mfma_f32_16x16x32_bf16 v[28:31], v[228:231], v[152:155], v[28:31]
    ds_read_b64_tr_b16 v[196:197], v11 offset:12288
    ds_read_b64_tr_b16 v[198:199], v11 offset:12800
    v_mfma_f32_16x16x32_bf16 v[104:107], v[228:231], v[156:159], v[104:107]
    ds_read_b64_tr_b16 v[200:201], v12 offset:12288
    v_mfma_f32_16x16x32_bf16 v[112:115], v[228:231], v[160:163], v[112:115]
    ds_read_b64_tr_b16 v[202:203], v12 offset:12800
    ds_read_b64_tr_b16 v[204:205], v74 offset:20480
    v_mfma_f32_16x16x32_bf16 v[244:247], v[224:227], v[252:255], v[244:247]
    ds_read_b64_tr_b16 v[206:207], v74 offset:20992
    ds_read_b64_tr_b16 v[240:241], v75 offset:20480
    v_mfma_f32_16x16x32_bf16 v[248:251], v[228:231], v[252:255], v[248:251]
    ds_read_b64_tr_b16 v[242:243], v75 offset:20992
    s_waitcnt lgkmcnt(8)
    v_mfma_f32_16x16x32_bf16 v[16:19], v[232:235], v[180:183], v[16:19]
    v_mfma_f32_16x16x32_bf16 v[24:27], v[232:235], v[184:187], v[24:27]
    v_mfma_f32_16x16x32_bf16 v[100:103], v[232:235], v[188:191], v[100:103]
    v_mfma_f32_16x16x32_bf16 v[108:111], v[232:235], v[192:195], v[108:111]
    v_mfma_f32_16x16x32_bf16 v[20:23], v[236:239], v[180:183], v[20:23]
    v_mfma_f32_16x16x32_bf16 v[28:31], v[236:239], v[184:187], v[28:31]
    v_mfma_f32_16x16x32_bf16 v[104:107], v[236:239], v[188:191], v[104:107]
    v_mfma_f32_16x16x32_bf16 v[112:115], v[236:239], v[192:195], v[112:115]
    v_mfma_f32_16x16x32_bf16 v[244:247], v[232:235], v[70:73], v[244:247]
    v_mfma_f32_16x16x32_bf16 v[248:251], v[236:239], v[70:73], v[248:251]
    s_waitcnt vmcnt(0)
    s_mov_b32 s51, 0
    v_readfirstlane_b32 s50, v15
    v_readfirstlane_b32 s47, v14
    s_cmp_eq_u32 s50, 0
    s_cbranch_scc0 L_o_20
L_o_20_r:
    s_add_u32 s51, s51, 1
    s_cmp_gt_u32 s51, 0x10000
    s_cbranch_scc1 L_o_20
    s_sleep 4
    buffer_load_dwordx2 v[14:15], off, s[36:39], 0 sc1
    s_waitcnt vmcnt(0)
    v_readfirstlane_b32 s50, v15
    v_readfirstlane_b32 s47, v14
    s_cmp_eq_u32 s50, 0
    s_cbranch_scc1 L_o_20_r
L_o_20:
    v_lshlrev_b32 v15, 2, v0
    s_waitcnt lgkmcnt(0)
    s_barrier
    v_mfma_f32_16x16x32_bf16 v[32:35], v[164:167], v[148:151], v[32:35]
    v_mfma_f32_16x16x32_bf16 v[36:39], v[168:171], v[148:151], v[36:39]
    v_cvt_pk_bf16_f32 v16, v16, v17
    v_cvt_pk_bf16_f32 v17, v18, v19
    v_mfma_f32_16x16x32_bf16 v[40:43], v[164:167], v[152:155], v[40:43]
    v_cvt_pk_bf16_f32 v18, v20, v21
    v_cvt_pk_bf16_f32 v19, v22, v23
    v_mfma_f32_16x16x32_bf16 v[44:47], v[168:171], v[152:155], v[44:47]
    ds_write_b128 v76, v[16:19] offset:0
    v_mfma_f32_16x16x32_bf16 v[32:35], v[196:199], v[180:183], v[32:35]
    v_cvt_pk_bf16_f32 v24, v24, v25
    v_cvt_pk_bf16_f32 v25, v26, v27
    v_mfma_f32_16x16x32_bf16 v[36:39], v[200:203], v[180:183], v[36:39]
    v_cvt_pk_bf16_f32 v26, v28, v29
    v_cvt_pk_bf16_f32 v27, v30, v31
    v_mfma_f32_16x16x32_bf16 v[40:43], v[196:199], v[184:187], v[40:43]
    ds_write_b128 v76, v[24:27] offset:1024
    v_mfma_f32_16x16x32_bf16 v[44:47], v[200:203], v[184:187], v[44:47]
    v_cvt_pk_bf16_f32 v100, v100, v101
    v_cvt_pk_bf16_f32 v101, v102, v103
    v_mfma_f32_16x16x32_bf16 v[116:119], v[164:167], v[156:159], v[116:119]
    v_cvt_pk_bf16_f32 v102, v104, v105
    v_cvt_pk_bf16_f32 v103, v106, v107
    v_mfma_f32_16x16x32_bf16 v[120:123], v[168:171], v[156:159], v[120:123]
    ds_write_b128 v76, v[100:103] offset:2048
    v_mfma_f32_16x16x32_bf16 v[124:127], v[164:167], v[160:163], v[124:127]
    v_cvt_pk_bf16_f32 v108, v108, v109
    v_cvt_pk_bf16_f32 v109, v110, v111
    v_mfma_f32_16x16x32_bf16 v[128:131], v[168:171], v[160:163], v[128:131]
    v_cvt_pk_bf16_f32 v110, v112, v113
    v_cvt_pk_bf16_f32 v111, v114, v115
    v_mfma_f32_16x16x32_bf16 v[116:119], v[196:199], v[188:191], v[116:119]
    ds_write_b128 v76, v[108:111] offset:3072
    v_mfma_f32_16x16x32_bf16 v[120:123], v[200:203], v[188:191], v[120:123]
    v_cvt_pk_bf16_f32 v244, v244, v245
    v_cvt_pk_bf16_f32 v245, v246, v247
    v_mfma_f32_16x16x32_bf16 v[124:127], v[196:199], v[192:195], v[124:127]
    v_cvt_pk_bf16_f32 v246, v248, v249
    v_cvt_pk_bf16_f32 v247, v250, v251
    v_mfma_f32_16x16x32_bf16 v[128:131], v[200:203], v[192:195], v[128:131]
    ds_write_b128 v78, v[244:247] offset:0
    v_mfma_f32_16x16x32_bf16 v[48:51], v[172:175], v[148:151], v[48:51]
L_TB1_0:
    s_cbranch_execz L_TB1_1
    s_nop 0
    v_mfma_f32_16x16x32_bf16 v[52:55], v[176:179], v[148:151], v[52:55]
    v_cvt_pk_bf16_f32 v32, v32, v33
    v_cvt_pk_bf16_f32 v33, v34, v35
    v_mfma_f32_16x16x32_bf16 v[56:59], v[172:175], v[152:155], v[56:59]
    v_cvt_pk_bf16_f32 v34, v36, v37
    v_mfma_f32_16x16x32_bf16 v[60:63], v[176:179], v[152:155], v[60:63]
    v_cvt_pk_bf16_f32 v35, v38, v39
    v_mfma_f32_16x16x32_bf16 v[48:51], v[204:207], v[180:183], v[48:51]
    ds_write_b128 v77, v[32:35] offset:0
    v_cvt_pk_bf16_f32 v40, v40, v41
    v_mfma_f32_16x16x32_bf16 v[52:55], v[240:243], v[180:183], v[52:55]
    v_cvt_pk_bf16_f32 v41, v42, v43
    v_mfma_f32_16x16x32_bf16 v[56:59], v[204:207], v[184:187], v[56:59]
    v_cvt_pk_bf16_f32 v42, v44, v45
    v_mfma_f32_16x16x32_bf16 v[60:63], v[240:243], v[184:187], v[60:63]
    v_cvt_pk_bf16_f32 v43, v46, v47
    ds_write_b128 v77, v[40:43] offset:1024
    v_mfma_f32_16x16x32_bf16 v[132:135], v[172:175], v[156:159], v[132:135]
    v_cvt_pk_bf16_f32 v116, v116, v117
    v_mfma_f32_16x16x32_bf16 v[136:139], v[176:179], v[156:159], v[136:139]
    v_cvt_pk_bf16_f32 v117, v118, v119
    v_mfma_f32_16x16x32_bf16 v[140:143], v[172:175], v[160:163], v[140:143]
    v_cvt_pk_bf16_f32 v118, v120, v121
    v_cvt_pk_bf16_f32 v119, v122, v123
    v_mfma_f32_16x16x32_bf16 v[144:147], v[176:179], v[160:163], v[144:147]
    ds_write_b128 v77, v[116:119] offset:2048
    v_mfma_f32_16x16x32_bf16 v[132:135], v[204:207], v[188:191], v[132:135]
    v_cvt_pk_bf16_f32 v124, v124, v125
    v_mfma_f32_16x16x32_bf16 v[136:139], v[240:243], v[188:191], v[136:139]
    v_cvt_pk_bf16_f32 v125, v126, v127
    v_cvt_pk_bf16_f32 v126, v128, v129
    v_mfma_f32_16x16x32_bf16 v[140:143], v[204:207], v[192:195], v[140:143]
    v_cvt_pk_bf16_f32 v127, v130, v131
    v_mfma_f32_16x16x32_bf16 v[144:147], v[240:243], v[192:195], v[144:147]
    ds_write_b128 v77, v[124:127] offset:3072
    v_cvt_pk_bf16_f32 v48, v48, v49
    v_cvt_pk_bf16_f32 v49, v50, v51
    v_cvt_pk_bf16_f32 v50, v52, v53
    v_cvt_pk_bf16_f32 v51, v54, v55
    ds_write_b128 v79, v[48:51] offset:0
    v_cvt_pk_bf16_f32 v56, v56, v57
    v_cvt_pk_bf16_f32 v57, v58, v59
    v_cvt_pk_bf16_f32 v58, v60, v61
    v_cvt_pk_bf16_f32 v59, v62, v63
    ds_write_b128 v79, v[56:59] offset:1024
    v_cvt_pk_bf16_f32 v132, v132, v133
    v_cvt_pk_bf16_f32 v133, v134, v135
    v_cvt_pk_bf16_f32 v134, v136, v137
    v_cvt_pk_bf16_f32 v135, v138, v139
    ds_write_b128 v79, v[132:135] offset:2048
    v_cvt_pk_bf16_f32 v140, v140, v141
    v_cvt_pk_bf16_f32 v141, v142, v143
    v_cvt_pk_bf16_f32 v142, v144, v145
    v_cvt_pk_bf16_f32 v143, v146, v147
    ds_write_b128 v79, v[140:143] offset:3072
    v_mov_b32 v126, 0x26a00
    v_mov_b32 v127, 1
    s_branch L_Bt
L_Bh:
    s_mov_b32 s56, s26
    s_mov_b32 s57, s27
    s_mov_b32 s58, 0x180000
    s_mov_b32 s59, 0x20000
    v_subrev_u32 v67, 0x18000, v3
    v_mov_b32 v126, 0x26a00
    v_mov_b32 v127, 1
    v_mov_b32 v16, 0
    v_mov_b32 v17, 0
    v_mov_b32 v18, 0
    v_mov_b32_e64 v19, 0
    ds_write_b128 v126, v[16:19]
    ds_write_b128 v126, v[16:19] offset:16
    s_mov_b64 s[20:21], s[30:31]
    s_mov_b64 s[24:25], s[34:35]
    s_mov_b64 s[32:33], s[36:37]
    s_mov_b64 s[28:29], s[38:39]
    s_mov_b64 s[36:37], s[4:5]
    s_mov_b64 s[16:17], s[6:7]
    s_add_u32 s50, s44, 2
    s_and_b32 s50, s50, 7
    s_lshl_b32 s66, s50, 7
    s_add_u32 s66, s66, s54
    s_mul_i32 s74, s50, 0x30000
    s_add_u32 s74, s74, s55
    s_add_u32 s50, s44, 3
    s_and_b32 s50, s50, 7
    s_lshl_b32 s67, s50, 7
    s_add_u32 s67, s67, s54
    s_mul_i32 s75, s50, 0x30000
    s_add_u32 s75, s75, s55
    s_add_u32 s50, s44, 4
    s_and_b32 s50, s50, 7
    s_lshl_b32 s68, s50, 7
    s_add_u32 s68, s68, s54
    s_mul_i32 s76, s50, 0x30000
    s_add_u32 s76, s76, s55
    s_add_u32 s50, s44, 5
    s_and_b32 s50, s50, 7
    s_lshl_b32 s69, s50, 7
    s_add_u32 s69, s69, s54
    s_mul_i32 s77, s50, 0x30000
    s_add_u32 s77, s77, s55
    s_add_u32 s50, s44, 6
    s_and_b32 s50, s50, 7
    s_lshl_b32 s70, s50, 7
    s_add_u32 s70, s70, s54
    s_mul_i32 s78, s50, 0x30000
    s_add_u32 s78, s78, s55
    s_add_u32 s50, s44, 7
    s_and_b32 s50, s50, 7
    s_lshl_b32 s71, s50, 7
    s_add_u32 s71, s71, s54
    s_mul_i32 s79, s50, 0x30000
    s_add_u32 s79, s79, s55
    s_mov_b32 s34, 0x400
    s_mov_b32 s35, 0x20000
    s_mov_b32 s18, 0x10000000
    s_mov_b32 s19, 0x20000
    s_mov_b32 s22, 0x80000
    s_mov_b32 s23, 0x20000
    s_mov_b32 s26, 0x80000
    s_mov_b32 s27, 0x20000
    s_mov_b32 s30, 0x200000
    s_mov_b32 s31, 0x20000
    s_mov_b32 s38, 0x100
    s_mov_b32 s39, 0x20000
    s_cmp_eq_u32 s40, 4
    s_cbranch_scc0 L_nomisc_21
    s_lshl_b32 s50, s44, 7
    v_add_u32 v20, s50, v13
    v_and_b32 v20, 0x3ff, v20
    s_add_u32 m0, s48, 0x25000
    s_nop 0
    buffer_load_dwordx4 v20, s[32:35], 0 offen lds
L_nomisc_21:
    v_and_b32 v16, 15, v0
    v_lshrrev_b32 v17, 4, v0
    v_bfe_u32 v18, v0, 1, 3
    v_xor_b32 v18, v17, v18
    v_lshlrev_b32_e64 v18, 4, v18
    v_lshl_add_u32 v18, v16, 7, v18
    v_add_u32 v10, 0x1e000, v18
    v_xor_b32 v11, 64, v10
    s_lshl_b32 s50, s42, 11
    v_add_u32 v110, s50, v18
    v_xor_b32 v111, 64, v110
    v_lshlrev_b32_e64 v112, 4, v17
    v_add_u32 v112, 0x26000, v112
    v_bfe_u32 v16, v0, 2, 2
    v_lshl_add_u32 v16, v17, 3, v16
    v_lshlrev_b32 v16, 7, v16
    s_lshr_b32 s50, s84, 1
    v_bfe_u32 v17, v0, 3, 1
    v_xor_b32 v17, s50, v17
    v_lshl_add_u32 v16, v17, 6, v16
    s_and_b32 s50, s84, 1
    s_lshl_b32 s50, s50, 5
    v_and_b32 v17, 3, v0
    v_lshl_add_u32 v16, v17, 3, v16
    v_add_u32 v12, s50, v16
    v_and_b32 v16, 16, v0
    v_lshlrev_b32 v16, 1, v16
    v_xor_b32 v12, v12, v16
    v_bfe_u32 v78, v0, 4, 1
    v_bfe_u32 v16, v0, 1, 2
    v_xor_b32 v78, v78, v16
    s_and_b32 s50, s84, 1
    s_lshl_b32 s50, s50, 1
    v_xor_b32 v78, s50, v78
    v_lshlrev_b32 v78, 4, v78
    v_and_b32 v16, 15, v0
    v_lshl_add_u32 v78, v16, 6, v78
    v_lshrrev_b32 v16, 5, v0
    v_lshl_add_u32 v78, v16, 3, v78
    s_lshr_b32 s50, s84, 1
    s_mul_i32 s50, s50, 9216
    s_add_u32 s50, s50, 0x0
    v_add_u32 v78, s50, v78
    s_waitcnt lgkmcnt(0)
    s_barrier
    s_add_u32 m0, s48, 0x0
    s_nop 0
    buffer_load_dwordx4 v1, s[8:11], s65 offen lds
    s_add_u32 m0, s48, 0xfffff000
    s_nop 0
    buffer_load_dwordx4 v65, s[8:11], s65 offen lds
    s_add_u32 m0, s48, 0x2000
    s_nop 0
    buffer_load_dwordx4 v2, s[8:11], s65 offen lds
    s_add_u32 m0, s48, 0x1000
    s_nop 0
    buffer_load_dwordx4 v66, s[8:11], s65 offen lds
    s_add_u32 m0, s48, 0x4000
    s_add_u32 s49, s73, 0x400
    buffer_load_dwordx4 v3, s[12:15], s49 offen lds
    s_add_u32 m0, s48, 0x3000
    s_add_u32 s49, s73, 0x400
    buffer_load_dwordx4 v67, s[12:15], s49 offen lds
    s_add_u32 m0, s48, 0x6000
    s_add_u32 s49, s73, 0x800
    buffer_load_dwordx4 v3, s[12:15], s49 offen lds
    s_add_u32 m0, s48, 0x5000
    s_add_u32 s49, s73, 0x800
    buffer_load_dwordx4 v67, s[12:15], s49 offen lds
    s_add_u32 m0, s48, 0x8000
    s_nop 0
    buffer_load_dwordx4 v3, s[12:15], s73 offen lds
    s_add_u32 m0, s48, 0x7000
    s_nop 0
    buffer_load_dwordx4 v67, s[12:15], s73 offen lds
    v_lshrrev_b32 v16, 3, v0
    v_lshrrev_b32 v17, 4, v0
    v_and_b32 v18, 7, v0
    v_xor_b32 v17, v17, v18
    v_lshlrev_b32 v17, 4, v17
    v_lshl_add_u32 v16, v16, 11, v17
    s_add_u32 s50, s44, s40
    s_and_b32 s50, s50, 7
    s_lshl_b32 s50, s50, 7
    s_lshl_b32 s51, s41, 17
    s_add_u32 s50, s50, s51
    s_sub_u32 s50, s50, 0x4000
    v_add_u32 v16, s50, v16
    v_xor_b32_e64 v17, 64, v16
    v_add_u32 v17, 0x400, v17
    v_xor_b32 v18, 0x200, v16
    v_xor_b32 v19, 0x200, v17
    s_lshl_b32 s50, s40, 11
    s_add_u32 m0, s50, 0x1e000
    s_nop 0
    buffer_load_dwordx4 v16, s[8:11], 0 offen lds
    s_add_u32 m0, s50, 0x1e400
    s_nop 0
    buffer_load_dwordx4 v17, s[8:11], 0 offen lds
    s_add_u32 m0, s50, 0x1c000
    s_nop 0
    buffer_load_dwordx4 v18, s[8:11], 0 offen lds
    s_add_u32 m0, s50, 0x1c400
    s_nop 0
    buffer_load_dwordx4 v19, s[8:11], 0 offen lds
    s_sub_u32 s50, s40, 4
    s_cmp_lt_u32 s50, 4
    s_cbranch_scc0 L_pw_22
    s_bitcmp1_b32 s40, 0
    s_cbranch_scc1 L_pw_22
    s_and_b32 s50, s41, 7
    s_mul_i32 s50, s50, 0x30000
    s_lshl_b32 s51, s42, 7
    s_add_u32 s50, s50, s51
    s_and_b32 s51, s40, 2
    s_lshl_b32 s51, s51, 10
    s_add_u32 s50, s50, s51
    v_mul_u32_u24 v249, 3072, v0
    v_add_u32 v249, s50, v249
    v_and_b32 v248, 1, v0
    v_lshlrev_b32 v248, 7, v248
    v_xor_b32_e64 v249, v249, v248
    s_mov_b32 s50, 0
    buffer_load_dword v248, v249, s[56:59], s50 offen
L_pw_22:
    ds_read_b32 v125, v126 offset:28
    s_waitcnt lgkmcnt(0)
    v_readfirstlane_b32 s50, v125
    s_cmp_lt_u32 s50, 4
    s_cbranch_scc0 L_o_23
L_o_23_r:
    s_sleep 1
    ds_read_b32 v125, v126 offset:28
    s_waitcnt lgkmcnt(0)
    v_readfirstlane_b32 s50, v125
    s_cmp_lt_u32 s50, 4
    s_cbranch_scc1 L_o_23_r
L_o_23:
    s_add_u32 m0, s48, 0xa000
    s_nop 0
    buffer_load_dwordx4 v1, s[8:11], s66 offen lds
    s_add_u32 m0, s48, 0x9000
    s_nop 0
    buffer_load_dwordx4 v65, s[8:11], s66 offen lds
    s_add_u32 m0, s48, 0xc000
    s_nop 0
    buffer_load_dwordx4 v2, s[8:11], s66 offen lds
    s_add_u32 m0, s48, 0xb000
    s_nop 0
    buffer_load_dwordx4 v66, s[8:11], s66 offen lds
    s_add_u32 m0, s48, 0xe000
    s_add_u32 s49, s74, 0x400
    buffer_load_dwordx4 v3, s[12:15], s49 offen lds
    s_add_u32 m0, s48, 0xd000
    s_add_u32 s49, s74, 0x400
    buffer_load_dwordx4 v67, s[12:15], s49 offen lds
    s_add_u32 m0, s48, 0x10000
    s_add_u32 s49, s74, 0x800
    buffer_load_dwordx4 v3, s[12:15], s49 offen lds
    v_add_u32 v110, 0x14000, v110
    v_add_u32 v111, 0x14000, v111
    s_cmp_eq_u32 s40, 4
    s_cbranch_scc0 L_ngr_24
    ds_read_b128 v[140:143], v110 offset:0
    ds_read_b128 v[160:163], v111 offset:0
L_ngr_24:
    s_add_u32 m0, s48, 0xf000
    s_add_u32 s49, s74, 0x800
    buffer_load_dwordx4 v67, s[12:15], s49 offen lds
    s_add_u32 m0, s48, 0x12000
    s_nop 0
    buffer_load_dwordx4 v3, s[12:15], s74 offen lds
    s_add_u32 m0, s48, 0x11000
    s_nop 0
    buffer_load_dwordx4 v67, s[12:15], s74 offen lds
    s_mov_b32 s52, 0x3fb8aa3b
    s_mov_b32 s53, 0x3fb8aa3b
    s_add_u32 s50, s45, 0
    s_and_b32 s50, s50, 3
    s_lshl_b32 s50, s50, 16
    s_lshl_b32 s51, s46, 7
    s_add_u32 s80, s50, s51
    s_add_u32 s50, s45, 1
    s_and_b32 s50, s50, 3
    s_lshl_b32 s50, s50, 16
    s_lshl_b32 s51, s46, 7
    s_add_u32 s81, s50, s51
    s_add_u32 s50, s45, 2
    s_and_b32 s50, s50, 3
    s_lshl_b32 s50, s50, 16
    s_lshl_b32 s51, s46, 7
    s_add_u32 s82, s50, s51
    s_add_u32 s50, s45, 3
    s_and_b32 s50, s50, 3
    s_lshl_b32 s50, s50, 16
    s_lshl_b32 s51, s46, 7
    s_add_u32 s83, s50, s51
    v_xor_b32 v68, 0x8000, v4
    s_lshl_b32 s50, s41, 2
    s_add_u32 s50, s50, s84
    s_lshl_b32 s51, s42, 1
    s_add_u32 s51, s51, s85
    s_lshl_b32 s54, s50, 5
    s_add_u32 s54, s54, s51
    s_lshl_b32 s55, s54, 7
    s_add_u32 s55, s55, 0x5a0000
    s_add_u32 s54, s54, 16
    s_lshl_b32 s54, s54, 11
    s_lshl_b32 s50, s41, 2
    s_lshr_b32 s51, s42, 1
    s_add_u32 s50, s50, s51
    s_lshl_b32 s50, s50, 5
    s_and_b32 s51, s42, 1
    s_add_u32 s50, s50, s51
    s_lshl_b32 s4, s50, 7
    s_add_u32 s4, s4, 0x5a0800
    s_cmp_eq_u32 s40, 4
    s_cselect_b32 s4, s4, 0
    s_lshl_b32 s5, s41, 9
    s_lshl_b32 s51, s42, 6
    s_add_u32 s5, s5, s51
    s_add_u32 s5, s5, 0x520000
    v_mov_b32 v244, -1
    v_mov_b32 v245, -1
    v_mov_b32 v246, -1
    v_mov_b32 v247, -1
    s_sub_u32 s3, s54, 2048
    s_waitcnt vmcnt(10) lgkmcnt(0)
    s_barrier
    s_add_u32 m0, s48, 0x14000
    s_nop 0
    buffer_load_dwordx4 v1, s[8:11], s67 offen lds
    s_add_u32 m0, s48, 0x13000
    s_nop 0
    buffer_load_dwordx4 v65, s[8:11], s67 offen lds
    s_add_u32 m0, s48, 0x16000
    s_nop 0
    buffer_load_dwordx4 v2, s[8:11], s67 offen lds
    s_add_u32 m0, s48, 0x15000
    s_nop 0
    buffer_load_dwordx4 v66, s[8:11], s67 offen lds
    s_add_u32 m0, s48, 0x18000
    s_add_u32 s49, s75, 0x400
    buffer_load_dwordx4 v3, s[12:15], s49 offen lds
    s_add_u32 m0, s48, 0x17000
    s_add_u32 s49, s75, 0x400
    buffer_load_dwordx4 v67, s[12:15], s49 offen lds
    s_add_u32 m0, s48, 0x1a000
    s_add_u32 s49, s75, 0x800
    buffer_load_dwordx4 v3, s[12:15], s49 offen lds
    v_add_u32 v110, 0xfffec000, v110
    v_add_u32 v111, 0xfffec000, v111
    s_cmp_eq_u32 s40, 4
    s_cbranch_scc0 L_ngr_25
    ds_read_b128 v[180:183], v110 offset:0
    ds_read_b128 v[200:203], v111 offset:0
    ds_read_b128 v[144:147], v112 offset:0
    ds_read_b128 v[164:167], v112 offset:64
    ds_read_b128 v[184:187], v112 offset:128
    ds_read_b128 v[204:207], v112 offset:192
L_ngr_25:
    s_add_u32 m0, s48, 0x19000
    s_add_u32 s49, s75, 0x800
    buffer_load_dwordx4 v67, s[12:15], s49 offen lds
    s_add_u32 m0, s48, 0x1c000
    s_nop 0
    buffer_load_dwordx4 v3, s[12:15], s75 offen lds
    s_add_u32 m0, s48, 0x1b000
    s_nop 0
    buffer_load_dwordx4 v67, s[12:15], s75 offen lds
    s_waitcnt lgkmcnt(0)
    s_cmp_eq_u32 s40, 4
    s_cbranch_scc0 L_ng_26
    s_setprio 2
    v_mfma_f32_16x16x32_bf16 v[24:27], v[144:147], v[140:143], 0
    v_mfma_f32_16x16x32_bf16 v[24:27], v[164:167], v[160:163], v[24:27]
    s_setprio 0
L_ng_26:
    v_lshrrev_b32 v88, 4, v0
    v_lshlrev_b32 v88, 2, v88
    v_and_b32 v89, 7, v0
    v_sub_u32 v88, v88, v89
    v_mov_b32 v90, 0xf149f2ca
    v_add_u32 v89, -1, v88
    v_cmp_gt_u32 vcc, 8, v89
    s_nop 1
    v_cndmask_b32 v80, v90, 0, vcc
    v_add_u32 v89, 0, v88
    v_cmp_gt_u32 vcc, 8, v89
    s_nop 1
    v_cndmask_b32 v81, v90, 0, vcc
    v_add_u32 v89, 1, v88
    v_cmp_gt_u32 vcc, 8, v89
    s_nop 1
    v_cndmask_b32 v82, v90, 0, vcc
    v_add_u32 v89, 2, v88
    v_cmp_gt_u32 vcc, 8, v89
    s_nop 1
    v_cndmask_b32 v83, v90, 0, vcc
    s_or_b32 s50, s41, s84
    s_cmp_eq_u32 s50, 0
    s_cselect_b32 s50, 32, 0
    v_cmp_gt_u32 vcc, s50, v0
    s_nop 1
    v_cndmask_b32 v84, v80, v90, vcc
    v_cndmask_b32 v85, v81, v90, vcc
    v_cndmask_b32 v86, v82, v90, vcc
    v_cndmask_b32 v87, v83, v90, vcc
    s_waitcnt vmcnt(10) lgkmcnt(0)
    s_barrier
    s_add_u32 m0, s48, 0x0
    s_nop 0
    buffer_load_dwordx4 v1, s[8:11], s68 offen lds
    s_cmp_eq_u32 s40, 4
    s_cbranch_scc0 L_ng_27
    s_setprio 2
    v_mfma_f32_16x16x32_bf16 v[24:27], v[184:187], v[180:183], v[24:27]
    v_mfma_f32_16x16x32_bf16 v[24:27], v[204:207], v[200:203], v[24:27]
    s_setprio 0
L_ng_27:
    s_add_u32 m0, s48, 0xfffff000
    s_nop 0
    buffer_load_dwordx4 v65, s[8:11], s68 offen lds
    s_add_u32 m0, s48, 0x2000
    s_nop 0
    buffer_load_dwordx4 v2, s[8:11], s68 offen lds
    s_add_u32 m0, s48, 0x1000
    s_nop 0
    buffer_load_dwordx4 v66, s[8:11], s68 offen lds
    s_add_u32 m0, s48, 0x4000
    s_add_u32 s49, s76, 0x400
    buffer_load_dwordx4 v3, s[12:15], s49 offen lds
    s_add_u32 m0, s48, 0x3000
    s_add_u32 s49, s76, 0x400
    buffer_load_dwordx4 v67, s[12:15], s49 offen lds
    s_add_u32 m0, s48, 0x6000
    s_add_u32 s49, s76, 0x800
    buffer_load_dwordx4 v3, s[12:15], s49 offen lds
    s_cmp_eq_u32 s40, 4
    s_cbranch_scc0 L_ngr_28
    ds_read_b128 v[140:143], v110 offset:40960
    ds_read_b128 v[160:163], v111 offset:40960
    ds_read_b128 v[144:147], v112 offset:256
    ds_read_b128 v[164:167], v112 offset:320
L_ngr_28:
    s_add_u32 m0, s48, 0x5000
    s_add_u32 s49, s76, 0x800
    buffer_load_dwordx4 v67, s[12:15], s49 offen lds
    s_add_u32 m0, s48, 0x8000
    s_nop 0
    buffer_load_dwordx4 v3, s[12:15], s76 offen lds
    s_add_u32 m0, s48, 0x7000
    s_nop 0
    buffer_load_dwordx4 v67, s[12:15], s76 offen lds
    s_mul_i32 s43, s85, 9216
    s_lshl_b32 s50, s84, 11
    s_add_u32 s43, s43, s50
    s_add_u32 s43, s43, 0x0
    v_and_b32 v88, 15, v0
    v_and_b32 v89, 8, v0
    v_add_u32 v88, v88, v89
    v_lshrrev_b32 v89, 4, v0
    v_bfe_u32 v90, v0, 1, 2
    v_xor_b32 v89, v89, v90
    v_lshlrev_b32 v89, 4, v89
    v_and_b32_e64 v91, 7, v0
    v_lshl_add_u32 v91, v91, 6, v89
    v_lshl_add_u32 v88, v88, 6, v89
    v_add_u32 v88, s43, v88
    s_lshl_b32 s50, s85, 13
    s_lshl_b32 s51, s84, 11
    s_add_u32 s50, s50, s51
    s_add_u32 s50, s50, 0x22000
    v_add_u32 v91, s50, v91
    s_waitcnt vmcnt(10) lgkmcnt(0)
    s_barrier
    s_add_u32 m0, s48, 0xa000
    s_nop 0
    buffer_load_dwordx4 v1, s[8:11], s69 offen lds
    s_cmp_eq_u32 s40, 4
    s_cbranch_scc0 L_ng_29
    s_setprio 2
    v_mfma_f32_16x16x32_bf16 v[24:27], v[144:147], v[140:143], v[24:27]
    v_mfma_f32_16x16x32_bf16 v[24:27], v[164:167], v[160:163], v[24:27]
    s_setprio 0
L_ng_29:
    s_add_u32 m0, s48, 0x9000
    s_nop 0
    buffer_load_dwordx4 v65, s[8:11], s69 offen lds
    s_add_u32 m0, s48, 0xc000
    s_nop 0
    buffer_load_dwordx4 v2, s[8:11], s69 offen lds
    s_add_u32 m0, s48, 0xb000
    s_nop 0
    buffer_load_dwordx4 v66, s[8:11], s69 offen lds
    s_add_u32 m0, s48, 0xe000
    s_add_u32 s49, s77, 0x400
    buffer_load_dwordx4 v3, s[12:15], s49 offen lds
    s_add_u32 m0, s48, 0xd000
    s_add_u32 s49, s77, 0x400
    buffer_load_dwordx4 v67, s[12:15], s49 offen lds
    s_add_u32 m0, s48, 0x10000
    s_add_u32 s49, s77, 0x800
    buffer_load_dwordx4 v3, s[12:15], s49 offen lds
    v_add_u32 v110, 0x14000, v110
    v_add_u32 v111, 0x14000, v111
    s_cmp_eq_u32 s40, 4
    s_cbranch_scc0 L_ngr_30
    ds_read_b128 v[180:183], v110 offset:0
    ds_read_b128 v[200:203], v111 offset:0
    ds_read_b128 v[184:187], v112 offset:384
    ds_read_b128 v[204:207], v112 offset:448
L_ngr_30:
    s_add_u32 m0, s48, 0xf000
    s_add_u32 s49, s77, 0x800
    buffer_load_dwordx4 v67, s[12:15], s49 offen lds
    s_add_u32 m0, s48, 0x12000
    s_nop 0
    buffer_load_dwordx4 v3, s[12:15], s77 offen lds
    s_add_u32 m0, s48, 0x11000
    s_nop 0
    buffer_load_dwordx4 v67, s[12:15], s77 offen lds
    v_lshrrev_b32 v89, 2, v0
    v_and_b32 v90, 8, v89
    v_add_u32 v89, v89, v90
    v_bfe_u32 v90, v0, 3, 2
    v_and_b32 v92, 3, v0
    v_xor_b32 v90, v90, v92
    v_lshlrev_b32_e64 v90, 4, v90
    v_lshl_add_u32 v89, v89, 6, v90
    s_add_u32 s43, s43, 18432
    v_add_u32 v89, s43, v89
    v_bfe_u32 v92, v0, 3, 1
    v_lshlrev_b32 v92, 6, v92
    v_bfe_u32 v93, v0, 4, 1
    v_lshl_add_u32 v92, v93, 5, v92
    v_lshrrev_b32 v93, 5, v0
    v_lshl_add_u32 v92, v93, 3, v92
    v_and_b32 v93, 7, v0
    v_add_u32 v92, v92, v93
    s_waitcnt vmcnt(10) lgkmcnt(0)
    s_barrier
    s_add_u32 m0, s48, 0x14000
    s_nop 0
    buffer_load_dwordx4 v1, s[8:11], s70 offen lds
    s_cmp_eq_u32 s40, 4
    s_cbranch_scc0 L_ng_31
    s_setprio 2
    v_mfma_f32_16x16x32_bf16 v[24:27], v[184:187], v[180:183], v[24:27]
    v_mfma_f32_16x16x32_bf16 v[24:27], v[204:207], v[200:203], v[24:27]
    s_setprio 0
L_ng_31:
    s_add_u32 m0, s48, 0x13000
    s_nop 0
    buffer_load_dwordx4 v65, s[8:11], s70 offen lds
    s_add_u32 m0, s48, 0x16000
    s_nop 0
    buffer_load_dwordx4 v2, s[8:11], s70 offen lds
    s_add_u32 m0, s48, 0x15000
    s_nop 0
    buffer_load_dwordx4 v66, s[8:11], s70 offen lds
    s_add_u32 m0, s48, 0x18000
    s_add_u32 s49, s78, 0x400
    buffer_load_dwordx4 v3, s[12:15], s49 offen lds
    s_add_u32 m0, s48, 0x17000
    s_add_u32 s49, s78, 0x400
    buffer_load_dwordx4 v67, s[12:15], s49 offen lds
    s_add_u32 m0, s48, 0x1a000
    s_add_u32 s49, s78, 0x800
    buffer_load_dwordx4 v3, s[12:15], s49 offen lds
    v_add_u32 v110, 0xfffec000, v110
    v_add_u32 v111, 0xfffec000, v111
    s_cmp_eq_u32 s40, 4
    s_cbranch_scc0 L_ngr_32
    ds_read_b128 v[140:143], v110 offset:0
    ds_read_b128 v[160:163], v111 offset:0
    ds_read_b128 v[144:147], v112 offset:512
    ds_read_b128 v[164:167], v112 offset:576
L_ngr_32:
    s_add_u32 m0, s48, 0x19000
    s_add_u32 s49, s78, 0x800
    buffer_load_dwordx4 v67, s[12:15], s49 offen lds
    s_add_u32 m0, s48, 0x1c000
    s_nop 0
    buffer_load_dwordx4 v3, s[12:15], s78 offen lds
    s_add_u32 m0, s48, 0x1b000
    s_nop 0
    buffer_load_dwordx4 v67, s[12:15], s78 offen lds
    v_lshlrev_b32 v92, 4, v92
    v_mov_b32 v96, 0x3f803f80
    v_mov_b32 v97, 0x3f803f80
    v_mov_b32 v98, 0x3f803f80
    v_mov_b32 v99, 0x3f803f80
    v_mov_b32 v208, 0
    v_mov_b32 v209, 0
    v_mov_b32 v210, 0
    v_mov_b32 v211, 0
    v_mov_b32 v212, 0
    v_mov_b32 v213, 0
    v_mov_b32 v214, 0
    v_mov_b32 v215, 0
    v_mov_b32 v216, 0
    v_mov_b32 v217, 0
    v_mov_b32 v218, 0
    v_mov_b32 v219, 0
    v_mov_b32 v220, 0
    v_mov_b32 v221, 0
    v_mov_b32 v222, 0
    v_mov_b32 v223, 0
    s_waitcnt vmcnt(10) lgkmcnt(0)
    s_barrier
    s_add_u32 m0, s48, 0x0
    s_nop 0
    buffer_load_dwordx4 v1, s[8:11], s71 offen lds
    s_cmp_eq_u32 s40, 4
    s_cbranch_scc0 L_ng_33
    s_setprio 2
    v_mfma_f32_16x16x32_bf16 v[24:27], v[144:147], v[140:143], v[24:27]
    v_mfma_f32_16x16x32_bf16 v[24:27], v[164:167], v[160:163], v[24:27]
    s_setprio 0
L_ng_33:
    s_add_u32 m0, s48, 0xfffff000
    s_nop 0
    buffer_load_dwordx4 v65, s[8:11], s71 offen lds
    s_add_u32 m0, s48, 0x2000
    s_nop 0
    buffer_load_dwordx4 v2, s[8:11], s71 offen lds
    s_add_u32 m0, s48, 0x1000
    s_nop 0
    buffer_load_dwordx4 v66, s[8:11], s71 offen lds
    s_add_u32 m0, s48, 0x4000
    s_add_u32 s49, s79, 0x400
    buffer_load_dwordx4 v3, s[12:15], s49 offen lds
    s_add_u32 m0, s48, 0x3000
    s_add_u32 s49, s79, 0x400
    buffer_load_dwordx4 v67, s[12:15], s49 offen lds
    s_add_u32 m0, s48, 0x6000
    s_add_u32 s49, s79, 0x800
    buffer_load_dwordx4 v3, s[12:15], s49 offen lds
    s_cmp_eq_u32 s40, 4
    s_cbranch_scc0 L_ngr_34
    ds_read_b128 v[180:183], v110 offset:40960
    ds_read_b128 v[200:203], v111 offset:40960
    ds_read_b128 v[184:187], v112 offset:640
    ds_read_b128 v[204:207], v112 offset:704
L_ngr_34:
    s_add_u32 m0, s48, 0x5000
    s_add_u32 s49, s79, 0x800
    buffer_load_dwordx4 v67, s[12:15], s49 offen lds
    s_add_u32 m0, s48, 0x8000
L_TB2_0:
    s_cbranch_execz L_TretB
    s_nop 0
    s_nop 0
    buffer_load_dwordx4 v3, s[12:15], s79 offen lds
    s_add_u32 m0, s48, 0x7000
    s_nop 0
    buffer_load_dwordx4 v67, s[12:15], s79 offen lds
    buffer_store_dwordx4 v[244:247], v13, s[16:19], s3 offen offset:0 sc1
    buffer_store_dwordx4 v[244:247], v13, s[16:19], s3 offen offset:1024 sc1
    buffer_store_dwordx4 v[244:247], v13, s[16:19], s3 offen offset:2048 sc1
    buffer_store_dwordx4 v[244:247], v13, s[16:19], s3 offen offset:3072 sc1
    s_sub_u32 s50, s55, 128
    s_mov_b64 exec, 0xffff
    buffer_store_dwordx4 v[244:247], v13, s[16:19], s50 offen sc1
    s_mov_b64 exec, -1
    s_waitcnt vmcnt(15) lgkmcnt(0)
    s_barrier
    buffer_load_dwordx2 v[14:15], off, s[36:39], 0 sc1
    s_add_u32 m0, s48, 0x12000
    s_nop 0
    buffer_load_dwordx4 v4, s[24:27], s81 offen lds
    s_cmp_eq_u32 s40, 4
    s_cbranch_scc0 L_ng_35
    s_setprio 2
    v_mfma_f32_16x16x32_bf16 v[24:27], v[184:187], v[180:183], v[24:27]
    v_mfma_f32_16x16x32_bf16 v[24:27], v[204:207], v[200:203], v[24:27]
    s_setprio 0
L_ng_35:
    s_add_u32 m0, s48, 0x11000
    s_nop 0
    buffer_load_dwordx4 v68, s[24:27], s81 offen lds
    s_add_u32 m0, s48, 0x10000
    s_nop 0
    buffer_load_dwordx4 v4, s[24:27], s80 offen lds
    s_add_u32 m0, s48, 0xf000
    s_nop 0
    buffer_load_dwordx4 v68, s[24:27], s80 offen lds
    v_add_u32 v110, 0x14000, v110
    v_add_u32 v111, 0x14000, v111
    s_cmp_eq_u32 s40, 4
    s_cbranch_scc0 L_ngr_36
    ds_read_b128 v[140:143], v110 offset:0
    ds_read_b128 v[160:163], v111 offset:0
    ds_read_b128 v[144:147], v112 offset:768
    ds_read_b128 v[164:167], v112 offset:832
L_ngr_36:
    s_waitcnt vmcnt(10) lgkmcnt(0)
    s_barrier
    s_add_u32 m0, s48, 0x14000
    s_nop 0
    buffer_load_dwordx4 v4, s[24:27], s82 offen lds
    s_cmp_eq_u32 s40, 4
    s_cbranch_scc0 L_ng_37
    s_setprio 2
    v_mfma_f32_16x16x32_bf16 v[24:27], v[144:147], v[140:143], v[24:27]
    v_mfma_f32_16x16x32_bf16 v[24:27], v[164:167], v[160:163], v[24:27]
    s_setprio 0
L_ng_37:
    s_add_u32 m0, s48, 0x13000
    s_nop 0
    buffer_load_dwordx4 v68, s[24:27], s82 offen lds
    s_add_u32 m0, s48, 0x16000
    s_nop 0
    buffer_load_dwordx4 v4, s[24:27], s83 offen lds
    s_add_u32 m0, s48, 0x15000
    s_nop 0
    buffer_load_dwordx4 v68, s[24:27], s83 offen lds
    s_add_u32 m0, s48, 0x18000
    s_add_u32 s49, s80, 0x40000
    buffer_load_dwordx4 v4, s[24:27], s49 offen lds
    s_add_u32 m0, s48, 0x17000
    s_add_u32 s49, s80, 0x40000
    buffer_load_dwordx4 v68, s[24:27], s49 offen lds
    s_add_u32 m0, s48, 0x1a000
    s_add_u32 s49, s81, 0x40000
    buffer_load_dwordx4 v4, s[24:27], s49 offen lds
    v_add_u32 v110, 0xfffec000, v110
    v_add_u32 v111, 0xfffec000, v111
    s_cmp_eq_u32 s40, 4
    s_cbranch_scc0 L_ngr_38
    ds_read_b128 v[180:183], v110 offset:0
    ds_read_b128 v[200:203], v111 offset:0
    ds_read_b128 v[184:187], v112 offset:896
    ds_read_b128 v[204:207], v112 offset:960
L_ngr_38:
    s_add_u32 m0, s48, 0x19000
    s_add_u32 s49, s81, 0x40000
    buffer_load_dwordx4 v68, s[24:27], s49 offen lds
    s_waitcnt lgkmcnt(0)
    s_barrier
    s_cmp_eq_u32 s40, 4
    s_cbranch_scc0 L_ng_39
    s_setprio 2
    v_mfma_f32_16x16x32_bf16 v[24:27], v[184:187], v[180:183], v[24:27]
    v_mfma_f32_16x16x32_bf16 v[24:27], v[204:207], v[200:203], v[24:27]
    s_setprio 0
L_ng_39:
    s_setprio 0
    s_cmp_eq_u32 s40, 4
    s_cbranch_scc0 L_nog_40
    s_mov_b64 exec, 0xff
    buffer_store_dwordx4 v[244:247], v13, s[16:19], s4 offen sc1
    s_mov_b64 exec, -1
    s_nop 0
    v_mul_f32 v24, s52, v24
    v_exp_f32 v24, -v24
    s_nop 0
    v_add_f32 v24, 1.0, v24
    v_rcp_f32 v24, v24
    v_lshlrev_b32 v25, 2, v0
    s_mov_b64 exec, 0xffff
    buffer_store_dword v24, v25, s[16:19], s5 offen sc1
    s_mov_b64 exec, -1
L_nog_40:
    s_waitcnt vmcnt(12)
    s_mov_b32 s51, 0
    v_readfirstlane_b32 s50, v15
    v_readfirstlane_b32 s47, v14
    s_cmp_eq_u32 s50, 0
    s_cbranch_scc0 L_o_41
L_o_41_r:
    s_add_u32 s51, s51, 1
    s_cmp_gt_u32 s51, 0x10000
    s_cbranch_scc1 L_o_41
    s_sleep 4
    buffer_load_dwordx2 v[14:15], off, s[36:39], 0 sc1
    s_waitcnt vmcnt(0)
    v_readfirstlane_b32 s50, v15
    v_readfirstlane_b32 s47, v14
    s_cmp_eq_u32 s50, 0
    s_cbranch_scc1 L_o_41_r
L_o_41:
    v_lshlrev_b32 v15, 2, v0
    s_add_u32 m0, s48, 0x1c000
    s_add_u32 s49, s82, 0x40000
    buffer_load_dwordx4 v4, s[24:27], s49 offen lds
    s_add_u32 m0, s48, 0x1b000
    s_add_u32 s49, s82, 0x40000
    buffer_load_dwordx4 v68, s[24:27], s49 offen lds
    s_add_u32 m0, s48, 0x1e000
    s_add_u32 s49, s83, 0x40000
    buffer_load_dwordx4 v4, s[24:27], s49 offen lds
    s_add_u32 m0, s48, 0x1d000
    s_add_u32 s49, s83, 0x40000
    buffer_load_dwordx4 v68, s[24:27], s49 offen lds
    s_and_b32 s79, s40, 1
    s_bfe_u32 s77, s40, 0x10001
    s_lshl_b32 s78, s45, 1
    s_add_u32 s78, s78, s79
    s_lshl_b32 s50, s78, 2
    s_lshr_b32 s51, s40, 1
    s_add_u32 s50, s50, s51
    s_lshl_b32 s50, s50, 14
    s_lshr_b32 s51, s80, 16
    s_lshl_b32 s51, s51, 12
    s_add_u32 s72, s50, s51
    s_lshr_b32 s51, s81, 16
    s_lshl_b32 s51, s51, 12
    s_add_u32 s73, s50, s51
    s_lshr_b32 s51, s82, 16
    s_lshl_b32 s51, s51, 12
    s_add_u32 s74, s50, s51
    s_lshr_b32 s51, s83, 16
    s_lshl_b32 s51, s51, 12
    s_add_u32 s75, s50, s51
    s_lshl_b32 s68, s78, 12
    s_lshl_b32 s50, s85, 18
    s_add_u32 s68, s68, s50
    s_add_u32 s68, s68, 0x560000
    s_lshl_b32 s76, s45, 6
    s_and_b32 s50, s40, 6
    s_lshl_b32 s50, s50, 3
    s_add_u32 s76, s76, s50
    s_add_u32 s76, s76, s79
    s_lshl_b32 s76, s76, 10
    s_lshl_b32 s50, s46, 7
    s_add_u32 s76, s76, s50
    v_and_b32 v28, 15, v0
    v_lshrrev_b32 v29, 4, v0
    v_lshlrev_b32_e64 v28, 4, v28
    v_lshl_add_u32 v119, v29, 9, v28
    v_bfe_u32 v28, v0, 2, 3
    v_lshrrev_b32 v29, 5, v0
    v_lshl_add_u32 v28, v29, 4, v28
    v_lshlrev_b32 v28, 7, v28
    v_bfe_u32 v29, v0, 3, 1
    v_lshl_add_u32 v28, v29, 6, v28
    v_bfe_u32 v29, v0, 4, 1
    v_lshl_add_u32 v28, v29, 5, v28
    v_and_b32 v29, 3, v0
    v_lshl_add_u32 v112, v29, 3, v28
    s_lshr_b32 s50, s40, 1
    s_lshl_b32 s50, s50, 15
    v_add_u32 v112, s50, v112
    v_xor_b32 v113, 64, v112
    v_xor_b32 v115, 32, v112
    v_xor_b32 v118, 32, v113
    v_and_b32 v11, 7, v0
    s_lshl_b32 s50, s77, 3
    v_add_u32 v11, s50, v11
    v_and_b32 v12, 1, v0
    v_add_u32 v12, 16, v12
    v_cmp_gt_u32 vcc, 32, v0
    s_nop 1
    v_cndmask_b32 v11, v12, v11, vcc
    v_lshlrev_b32 v11, 7, v11
    v_and_b32 v5, 31, v0
    v_lshlrev_b32_e64 v5, 2, v5
    s_lshl_b32 s69, s78, 7
    s_add_u32 s69, s69, 0x520000
    s_add_u32 m0, s48, 0xe000
    s_add_u32 s49, s83, 0x40000
    buffer_load_dwordx4 v4, s[20:23], s49 offen lds
    s_add_u32 m0, s48, 0xd000
    s_add_u32 s49, s83, 0x40000
    buffer_load_dwordx4 v68, s[20:23], s49 offen lds
    s_add_u32 m0, s48, 0xc000
    s_add_u32 s49, s82, 0x40000
    buffer_load_dwordx4 v4, s[20:23], s49 offen lds
    s_add_u32 m0, s48, 0xb000
    s_add_u32 s49, s82, 0x40000
    buffer_load_dwordx4 v68, s[20:23], s49 offen lds
    s_add_u32 m0, s48, 0xa000
    s_add_u32 s49, s81, 0x40000
    buffer_load_dwordx4 v4, s[20:23], s49 offen lds
    s_add_u32 m0, s48, 0x9000
    s_add_u32 s49, s81, 0x40000
    buffer_load_dwordx4 v68, s[20:23], s49 offen lds
L_Bt:
L_TB0_1:
    s_cbranch_execz L_TretB
    s_nop 0
    s_waitcnt lgkmcnt(0)
    s_barrier
    s_mov_b32 exec_lo, 0xff00ff
    s_mov_b32 exec_hi, 0xff00ff
    ds_read_b64 v[208:209], v91 offset:0
    ds_read_b64 v[212:213], v91 offset:512
    ds_read_b64 v[216:217], v91 offset:1024
    ds_read_b64 v[220:221], v91 offset:1536
    s_mov_b32 exec_lo, 0xff00ff00
    s_mov_b32 exec_hi, 0xff00ff00
    ds_read_b64 v[210:211], v91 offset:8
    ds_read_b64 v[214:215], v91 offset:520
    ds_read_b64 v[218:219], v91 offset:1032
    ds_read_b64 v[222:223], v91 offset:1544
    s_mov_b64 exec, -1
    ds_read_b128 v[128:131], v88 offset:0
    ds_read_b128 v[132:135], v88 offset:512
    ds_read_b128 v[136:139], v88 offset:1024
    ds_read_b128 v[140:143], v88 offset:1536
    ds_read_b64_tr_b16 v[144:145], v89 offset:0
    ds_read_b64_tr_b16 v[146:147], v89 offset:8
    ds_read_b64_tr_b16 v[148:149], v89 offset:512
    ds_read_b64_tr_b16 v[150:151], v89 offset:520
    ds_read_b64_tr_b16 v[152:153], v89 offset:1024
    ds_read_b64_tr_b16 v[154:155], v89 offset:1032
    ds_read_b64_tr_b16 v[156:157], v89 offset:1536
    ds_read_b64_tr_b16 v[158:159], v89 offset:1544
    v_mov_b32 v224, 0
    v_mov_b32 v225, 0
    v_mov_b32 v226, 0
    v_mov_b32 v227, 0
    v_mov_b32 v228, 0
    v_mov_b32 v229, 0
    v_mov_b32 v230, 0
    v_mov_b32 v231, 0
    v_mov_b32 v232, 0
    v_mov_b32 v233, 0
    v_mov_b32 v234, 0
    v_mov_b32 v235, 0
    v_mov_b32 v236, 0
    v_mov_b32 v237, 0
    v_mov_b32 v238, 0
    v_mov_b32 v239, 0
    s_waitcnt lgkmcnt(11)
    v_mfma_f32_16x16x32_bf16 v[160:163], v[128:131], v[208:211], v[84:87]
    s_waitcnt lgkmcnt(10)
    v_mfma_f32_16x16x32_bf16 v[164:167], v[132:135], v[212:215], v[84:87]
    s_waitcnt lgkmcnt(9)
    v_mfma_f32_16x16x32_bf16 v[168:171], v[136:139], v[216:219], v[80:83]
    s_waitcnt lgkmcnt(8)
    v_mfma_f32_16x16x32_bf16 v[172:175], v[140:143], v[220:223], v[80:83]
    s_cmp_lg_u32 s4, 0
    s_cbranch_scc0 L_o_42
L_o_42_r:
    s_waitcnt vmcnt(10)
    s_mov_b32 exec_hi, 0
    buffer_store_dword v14, v15, s[16:19], s4 offen sc1
    s_mov_b64 exec, -1
L_o_42:
    s_mov_b32 exec_hi, 0
    buffer_store_dword v14, v15, s[16:19], s55 offen sc1
    s_mov_b64 exec, -1
    v_max3_f32 v100, v160, v161, v162
    v_max3_f32 v101, v164, v165, v166
    v_max3_f32 v102, v168, v169, v170
    v_max3_f32 v103, v172, v173, v174
    v_max_f32 v100, v100, v163
    v_max_f32 v101, v101, v167
    v_max_f32 v102, v102, v171
    v_max_f32 v103, v103, v175
    v_permlane16_swap_b32 v100, v101
    s_nop 0
    v_permlane16_swap_b32 v102, v103
    v_max_f32 v100, v100, v101
    v_max_f32 v102, v102, v103
    s_nop 1
    v_permlane32_swap_b32 v100, v102
    v_max_f32 v100, v100, v102
    s_mov_b32 s52, 0x3EB8AA3B
    v_mul_f32 v100, s52, v100
    v_mov_b32 v104, v100
    s_nop 1
    v_permlane32_swap_b32 v100, v104
    v_mov_b32 v102, v100
    v_mov_b32_e64 v106, v104
    s_nop 0
    v_permlane16_swap_b32 v100, v102
    v_permlane16_swap_b32 v104, v106
    v_fma_f32 v160, v160, s52, -v100
    v_fma_f32 v161, v161, s52, -v100
    v_fma_f32 v162, v162, s52, -v100
    v_fma_f32 v163, v163, s52, -v100
    v_fma_f32 v164, v164, s52, -v102
    v_fma_f32 v165, v165, s52, -v102
    v_fma_f32 v166, v166, s52, -v102
    v_fma_f32 v167, v167, s52, -v102
    v_fma_f32 v168, v168, s52, -v104
    v_fma_f32 v169, v169, s52, -v104
    v_fma_f32 v170, v170, s52, -v104
    v_fma_f32 v171, v171, s52, -v104
    v_fma_f32 v172, v172, s52, -v106
    v_fma_f32 v173, v173, s52, -v106
    v_fma_f32 v174, v174, s52, -v106
    v_fma_f32 v175, v175, s52, -v106
    v_exp_f32 v160, v160
    v_exp_f32 v161, v161
    v_exp_f32 v162, v162
    v_exp_f32 v163, v163
    v_exp_f32 v164, v164
    v_exp_f32 v165, v165
    v_exp_f32 v166, v166
    v_exp_f32 v167, v167
    v_exp_f32 v168, v168
    v_exp_f32 v169, v169
    v_exp_f32 v170, v170
    v_exp_f32 v171, v171
    v_exp_f32 v172, v172
    v_exp_f32 v173, v173
    v_exp_f32 v174, v174
    v_exp_f32 v175, v175
    s_mov_b32 exec_lo, 0xff00ff
    s_mov_b32 exec_hi, 0xff00ff
    v_cvt_pk_bf16_f32 v224, v160, v161
    v_cvt_pk_bf16_f32 v225, v162, v163
    v_cvt_pk_bf16_f32 v228, v164, v165
    v_cvt_pk_bf16_f32 v229, v166, v167
    v_cvt_pk_bf16_f32 v232, v168, v169
    v_cvt_pk_bf16_f32 v233, v170, v171
    v_cvt_pk_bf16_f32 v236, v172, v173
    v_cvt_pk_bf16_f32 v237, v174, v175
    s_mov_b32 exec_lo, 0xff00ff00
    s_mov_b32 exec_hi, 0xff00ff00
    v_cvt_pk_bf16_f32 v226, v160, v161
    v_cvt_pk_bf16_f32 v227, v162, v163
    v_cvt_pk_bf16_f32 v230, v164, v165
    v_cvt_pk_bf16_f32 v231, v166, v167
    v_cvt_pk_bf16_f32 v234, v168, v169
    v_cvt_pk_bf16_f32 v235, v170, v171
    v_cvt_pk_bf16_f32 v238, v172, v173
    v_cvt_pk_bf16_f32 v239, v174, v175
    s_mov_b64 exec, -1
    s_waitcnt lgkmcnt(0)
    v_mfma_f32_16x16x32_bf16 v[180:183], v[96:99], v[224:227], 0
    v_mfma_f32_16x16x32_bf16 v[176:179], v[144:147], v[224:227], 0
    v_mfma_f32_16x16x32_bf16 v[188:191], v[96:99], v[228:231], 0
    v_mfma_f32_16x16x32_bf16 v[184:187], v[148:151], v[228:231], 0
    v_mfma_f32_16x16x32_bf16 v[196:199], v[96:99], v[232:235], 0
    v_mfma_f32_16x16x32_bf16 v[192:195], v[152:155], v[232:235], 0
    v_mfma_f32_16x16x32_bf16 v[204:207], v[96:99], v[236:239], 0
    v_mfma_f32_16x16x32_bf16 v[200:203], v[156:159], v[236:239], 0
    s_nop 0
    v_rcp_f32 v180, v180
    s_nop 0
    v_rcp_f32 v188, v188
    s_nop 0
    v_rcp_f32 v196, v196
    s_nop 0
    v_rcp_f32 v204, v204
    v_mul_f32 v176, v176, v180
    v_mul_f32 v177, v177, v180
    v_mul_f32 v178, v178, v180
    v_mul_f32 v179, v179, v180
    v_mul_f32 v184, v184, v188
    v_mul_f32 v185, v185, v188
    v_mul_f32 v186, v186, v188
    v_mul_f32 v187, v187, v188
    v_mul_f32 v192, v192, v196
    v_mul_f32 v193, v193, v196
    v_mul_f32 v194, v194, v196
    v_mul_f32 v195, v195, v196
    v_mul_f32 v200, v200, v204
    v_mul_f32 v201, v201, v204
    v_mul_f32 v202, v202, v204
    v_mul_f32 v203, v203, v204
    v_cvt_pk_bf16_f32 v128, v176, v177
    v_cvt_pk_bf16_f32 v129, v178, v179
    v_cvt_pk_bf16_f32 v130, v184, v185
    v_cvt_pk_bf16_f32 v131, v186, v187
    v_cvt_pk_bf16_f32 v132, v192, v193
    v_cvt_pk_bf16_f32 v133, v194, v195
    v_cvt_pk_bf16_f32 v134, v200, v201
    v_cvt_pk_bf16_f32 v135, v202, v203
    v_permlane32_swap_b32 v128, v130
    v_permlane32_swap_b32 v129, v131
    buffer_store_dwordx4 v[128:131], v92, s[16:19], s54 offen offset:0 sc1
    v_permlane32_swap_b32 v132, v134
    v_permlane32_swap_b32 v133, v135
    buffer_store_dwordx4 v[132:135], v92, s[16:19], s54 offen offset:256 sc1
    s_cmp_eq_u32 s85, 0
    s_cbranch_scc0 L_Bp
    s_barrier
    s_add_u32 m0, s48, 0x0
    s_nop 0
    buffer_load_dwordx4 v4, s[20:23], s80 offen lds
    s_add_u32 m0, s48, 0x2000
    s_nop 0
    buffer_load_dwordx4 v4, s[20:23], s81 offen lds
    s_add_u32 m0, s48, 0x4000
    s_nop 0
    buffer_load_dwordx4 v4, s[20:23], s82 offen lds
    s_add_u32 m0, s48, 0x6000
    s_nop 0
    buffer_load_dwordx4 v4, s[20:23], s83 offen lds
    s_add_u32 m0, s48, 0x8000
    s_add_u32 s49, s80, 0x40000
    buffer_load_dwordx4 v4, s[20:23], s49 offen lds
    s_add_u32 m0, s48, 0x1000
    s_nop 0
    buffer_load_dwordx4 v68, s[20:23], s80 offen lds
    s_add_u32 m0, s48, 0x3000
    s_nop 0
    buffer_load_dwordx4 v68, s[20:23], s81 offen lds
    s_add_u32 m0, s48, 0x5000
    s_nop 0
    buffer_load_dwordx4 v68, s[20:23], s82 offen lds
    s_add_u32 m0, s48, 0x7000
    s_nop 0
    buffer_load_dwordx4 v68, s[20:23], s83 offen lds
    s_add_u32 m0, s48, 0x9000
    s_add_u32 s49, s80, 0x40000
    buffer_load_dwordx4 v68, s[20:23], s49 offen lds
    s_and_b32 s79, s40, 1
    s_bfe_u32 s77, s40, 0x10001
    s_lshl_b32 s78, s45, 1
    s_add_u32 s78, s78, s79
    s_lshl_b32 s50, s78, 2
    s_lshr_b32 s51, s40, 1
    s_add_u32 s50, s50, s51
    s_lshl_b32 s50, s50, 14
    s_lshr_b32 s51, s80, 16
    s_lshl_b32 s51, s51, 12
    s_add_u32 s72, s50, s51
    s_lshr_b32 s51, s81, 16
    s_lshl_b32 s51, s51, 12
    s_add_u32 s73, s50, s51
    s_lshr_b32 s51, s82, 16
    s_lshl_b32 s51, s51, 12
    s_add_u32 s74, s50, s51
    s_lshr_b32 s51, s83, 16
    s_lshl_b32 s51, s51, 12
    s_add_u32 s75, s50, s51
    s_lshl_b32 s68, s78, 12
    s_lshl_b32 s50, s85, 18
    s_add_u32 s68, s68, s50
    s_add_u32 s68, s68, 0x560000
    s_lshl_b32 s76, s45, 6
    s_and_b32 s50, s40, 6
    s_lshl_b32 s50, s50, 3
    s_add_u32 s76, s76, s50
    s_add_u32 s76, s76, s79
    s_lshl_b32 s76, s76, 10
    s_lshl_b32 s50, s46, 7
    s_add_u32 s76, s76, s50
    v_and_b32 v17, 15, v0
    v_lshrrev_b32 v18, 4, v0
    v_lshlrev_b32_e64 v17, 4, v17
    v_lshl_add_u32 v119, v18, 9, v17
    v_bfe_u32 v17, v0, 2, 3
    v_lshrrev_b32 v18, 5, v0
    v_lshl_add_u32 v17, v18, 4, v17
    v_lshlrev_b32 v17, 7, v17
    v_bfe_u32 v18, v0, 3, 1
    v_lshl_add_u32 v17, v18, 6, v17
    v_bfe_u32 v18, v0, 4, 1
    v_lshl_add_u32 v17, v18, 5, v17
    v_and_b32 v18, 3, v0
    v_lshl_add_u32 v112, v18, 3, v17
    s_lshr_b32 s50, s40, 1
    s_lshl_b32 s50, s50, 15
    v_add_u32 v112, s50, v112
    v_xor_b32 v113, 64, v112
    v_xor_b32 v115, 32, v112
    v_xor_b32 v118, 32, v113
    s_branch L_P2A
L_Bp:
L_TB1_1:
    s_cbranch_execz L_TretB
    s_nop 0
    buffer_load_dword v12, v11, s[16:19], s68 offen sc1
    s_waitcnt vmcnt(4)
    s_barrier
    ds_read_b64_tr_b16 v[128:129], v112 offset:0
    ds_read_b64_tr_b16 v[130:131], v112 offset:1024
    ds_read_b64_tr_b16 v[132:133], v115 offset:0
    ds_read_b64_tr_b16 v[134:135], v115 offset:1024
    ds_read_b64_tr_b16 v[136:137], v113 offset:0
    ds_read_b64_tr_b16 v[138:139], v113 offset:1024
    ds_read_b64_tr_b16 v[140:141], v118 offset:0
    ds_read_b64_tr_b16 v[142:143], v118 offset:1024
    ds_read_b64_tr_b16 v[144:145], v112 offset:4096
    ds_read_b64_tr_b16 v[146:147], v112 offset:5120
    ds_read_b64_tr_b16 v[148:149], v115 offset:4096
    ds_read_b64_tr_b16 v[150:151], v115 offset:5120
    ds_read_b64_tr_b16 v[152:153], v113 offset:4096
    ds_read_b64_tr_b16 v[154:155], v113 offset:5120
    ds_read_b64_tr_b16 v[156:157], v118 offset:4096
    ds_read_b64_tr_b16 v[158:159], v118 offset:5120
    ds_read_b64_tr_b16 v[160:161], v112 offset:8192
    ds_read_b64_tr_b16 v[162:163], v112 offset:9216
    ds_read_b64_tr_b16 v[164:165], v115 offset:8192
    ds_read_b64_tr_b16 v[166:167], v115 offset:9216
    ds_read_b64_tr_b16 v[168:169], v113 offset:8192
    ds_read_b64_tr_b16 v[170:171], v113 offset:9216
    ds_read_b64_tr_b16 v[172:173], v118 offset:8192
    ds_read_b64_tr_b16 v[174:175], v118 offset:9216
    ds_read_b64_tr_b16 v[176:177], v112 offset:12288
    ds_read_b64_tr_b16 v[178:179], v112 offset:13312
    ds_read_b64_tr_b16 v[180:181], v115 offset:12288
    ds_read_b64_tr_b16 v[182:183], v115 offset:13312
    ds_read_b64_tr_b16 v[184:185], v113 offset:12288
    ds_read_b64_tr_b16 v[186:187], v113 offset:13312
    ds_read_b64_tr_b16 v[188:189], v118 offset:12288
    ds_read_b64_tr_b16 v[190:191], v118 offset:13312
    ds_read_b64_tr_b16 v[192:193], v112 offset:16384
    ds_read_b64_tr_b16 v[194:195], v112 offset:17408
    ds_read_b64_tr_b16 v[196:197], v115 offset:16384
    ds_read_b64_tr_b16 v[198:199], v115 offset:17408
    ds_read_b64_tr_b16 v[200:201], v113 offset:16384
    ds_read_b64_tr_b16 v[202:203], v113 offset:17408
    ds_read_b64_tr_b16 v[204:205], v118 offset:16384
    ds_read_b64_tr_b16 v[206:207], v118 offset:17408
    ds_read_b64_tr_b16 v[208:209], v112 offset:20480
    ds_read_b64_tr_b16 v[210:211], v112 offset:21504
    ds_read_b64_tr_b16 v[212:213], v115 offset:20480
    ds_read_b64_tr_b16 v[214:215], v115 offset:21504
    ds_read_b64_tr_b16 v[216:217], v113 offset:20480
    ds_read_b64_tr_b16 v[218:219], v113 offset:21504
    ds_read_b64_tr_b16 v[220:221], v118 offset:20480
    ds_read_b64_tr_b16 v[222:223], v118 offset:21504
    ds_read_b64_tr_b16 v[224:225], v112 offset:24576
    ds_read_b64_tr_b16 v[226:227], v112 offset:25600
    ds_read_b64_tr_b16 v[228:229], v115 offset:24576
    ds_read_b64_tr_b16 v[230:231], v115 offset:25600
    ds_read_b64_tr_b16 v[232:233], v113 offset:24576
    ds_read_b64_tr_b16 v[234:235], v113 offset:25600
    ds_read_b64_tr_b16 v[236:237], v118 offset:24576
    ds_read_b64_tr_b16 v[238:239], v118 offset:25600
    ds_read_b64_tr_b16 v[240:241], v112 offset:28672
    ds_read_b64_tr_b16 v[242:243], v112 offset:29696
    ds_read_b64_tr_b16 v[244:245], v115 offset:28672
    ds_read_b64_tr_b16 v[246:247], v115 offset:29696
    ds_read_b64_tr_b16 v[248:249], v113 offset:28672
    ds_read_b64_tr_b16 v[250:251], v113 offset:29696
    ds_read_b64_tr_b16 v[252:253], v118 offset:28672
    ds_read_b64_tr_b16 v[254:255], v118 offset:29696
    s_mov_b64 exec, 1
    ds_add_u32 v126, v127 offset:24
    s_mov_b64 exec, -1
    s_waitcnt vmcnt(0)
    v_cmp_ne_u32 vcc, s47, v12
    s_mov_b32 s51, 1
    s_cbranch_vccz L_o_43
L_o_43_r:
    s_add_u32 s51, s51, 1
    s_cmp_gt_u32 s51, 0x10000
    s_cbranch_scc1 L_o_43
    s_sleep 2
    buffer_load_dword v12, v11, s[16:19], s68 offen sc1
    s_waitcnt vmcnt(0)
    v_cmp_ne_u32 vcc, s47, v12
    s_nop 0
    s_cbranch_vccnz L_o_43_r
L_o_43:
    buffer_load_dword v6, v5, s[16:19], s69 offen sc1
    s_branch L_G
L_P2B:
L_TP0_0:
    s_cbranch_execz L_TP0_1
    s_nop 0
    ds_read_b64_tr_b16 v[128:129], v112 offset:0
    ds_read_b64_tr_b16 v[130:131], v112 offset:1024
    ds_read_b64_tr_b16 v[132:133], v115 offset:0
    ds_read_b64_tr_b16 v[134:135], v115 offset:1024
    ds_read_b64_tr_b16 v[136:137], v113 offset:0
    ds_read_b64_tr_b16 v[138:139], v113 offset:1024
    ds_read_b64_tr_b16 v[140:141], v118 offset:0
    ds_read_b64_tr_b16 v[142:143], v118 offset:1024
    ds_read_b64_tr_b16 v[144:145], v112 offset:4096
    ds_read_b64_tr_b16 v[146:147], v112 offset:5120
    ds_read_b64_tr_b16 v[148:149], v115 offset:4096
    ds_read_b64_tr_b16 v[150:151], v115 offset:5120
    ds_read_b64_tr_b16 v[152:153], v113 offset:4096
    ds_read_b64_tr_b16 v[154:155], v113 offset:5120
    ds_read_b64_tr_b16 v[156:157], v118 offset:4096
    ds_read_b64_tr_b16 v[158:159], v118 offset:5120
    ds_read_b64_tr_b16 v[160:161], v112 offset:8192
    ds_read_b64_tr_b16 v[162:163], v112 offset:9216
    ds_read_b64_tr_b16 v[164:165], v115 offset:8192
    ds_read_b64_tr_b16 v[166:167], v115 offset:9216
    ds_read_b64_tr_b16 v[168:169], v113 offset:8192
    ds_read_b64_tr_b16 v[170:171], v113 offset:9216
    ds_read_b64_tr_b16 v[172:173], v118 offset:8192
    ds_read_b64_tr_b16 v[174:175], v118 offset:9216
    ds_read_b64_tr_b16 v[176:177], v112 offset:12288
    ds_read_b64_tr_b16 v[178:179], v112 offset:13312
    ds_read_b64_tr_b16 v[180:181], v115 offset:12288
    ds_read_b64_tr_b16 v[182:183], v115 offset:13312
    ds_read_b64_tr_b16 v[184:185], v113 offset:12288
    ds_read_b64_tr_b16 v[186:187], v113 offset:13312
    ds_read_b64_tr_b16 v[188:189], v118 offset:12288
    ds_read_b64_tr_b16 v[190:191], v118 offset:13312
    ds_read_b64_tr_b16 v[192:193], v112 offset:16384
    ds_read_b64_tr_b16 v[194:195], v112 offset:17408
    ds_read_b64_tr_b16 v[196:197], v115 offset:16384
    ds_read_b64_tr_b16 v[198:199], v115 offset:17408
    ds_read_b64_tr_b16 v[200:201], v113 offset:16384
    ds_read_b64_tr_b16 v[202:203], v113 offset:17408
    ds_read_b64_tr_b16 v[204:205], v118 offset:16384
    ds_read_b64_tr_b16 v[206:207], v118 offset:17408
    ds_read_b64_tr_b16 v[208:209], v112 offset:20480
    ds_read_b64_tr_b16 v[210:211], v112 offset:21504
    ds_read_b64_tr_b16 v[212:213], v115 offset:20480
    ds_read_b64_tr_b16 v[214:215], v115 offset:21504
    ds_read_b64_tr_b16 v[216:217], v113 offset:20480
    ds_read_b64_tr_b16 v[218:219], v113 offset:21504
    ds_read_b64_tr_b16 v[220:221], v118 offset:20480
    ds_read_b64_tr_b16 v[222:223], v118 offset:21504
    ds_read_b64_tr_b16 v[224:225], v112 offset:24576
    ds_read_b64_tr_b16 v[226:227], v112 offset:25600
    ds_read_b64_tr_b16 v[228:229], v115 offset:24576
    ds_read_b64_tr_b16 v[230:231], v115 offset:25600
    ds_read_b64_tr_b16 v[232:233], v113 offset:24576
    ds_read_b64_tr_b16 v[234:235], v113 offset:25600
    ds_read_b64_tr_b16 v[236:237], v118 offset:24576
    ds_read_b64_tr_b16 v[238:239], v118 offset:25600
    ds_read_b64_tr_b16 v[240:241], v112 offset:28672
    ds_read_b64_tr_b16 v[242:243], v112 offset:29696
    ds_read_b64_tr_b16 v[244:245], v115 offset:28672
    ds_read_b64_tr_b16 v[246:247], v115 offset:29696
    ds_read_b64_tr_b16 v[248:249], v113 offset:28672
    ds_read_b64_tr_b16 v[250:251], v113 offset:29696
    ds_read_b64_tr_b16 v[252:253], v118 offset:28672
    ds_read_b64_tr_b16 v[254:255], v118 offset:29696
    s_waitcnt vmcnt(0) lgkmcnt(0)
    s_mov_b64 exec, 1
    ds_add_u32 v126, v127 offset:24
    s_mov_b64 exec, -1
    v_cmp_ne_u32 vcc, s47, v12
    s_mov_b32 s51, 1
    s_cbranch_vccz L_o_44
L_o_44_r:
    s_add_u32 s51, s51, 1
    s_cmp_gt_u32 s51, 0x10000
    s_cbranch_scc1 L_o_44
    s_sleep 2
    buffer_load_dword v12, v11, s[16:19], s68 offen sc1
L_TP0_1:
    s_cbranch_execz L_TP0_2
    s_nop 0
    s_waitcnt vmcnt(0)
    v_cmp_ne_u32 vcc, s47, v12
    s_nop 0
    s_cbranch_vccnz L_o_44_r
L_o_44:
    s_setprio 1
    buffer_load_dword v6, v5, s[16:19], s69 offen sc1
    s_branch L_G
L_P2A:
    s_bfe_u32 s51, s40, 0x10001
    s_lshl_b32 s50, s51, 3
    v_and_b32 v114, 6, v0
    v_add_u32 v114, s50, v114
    v_lshlrev_b32 v114, 7, v114
    s_waitcnt vmcnt(0)
L_P2A2:
    s_mov_b64 exec, 1
    ds_add_u32 v126, v127 offset:24
    s_mov_b64 exec, -1
    ds_read_b32 v125, v126 offset:24
    s_waitcnt lgkmcnt(0)
    v_readfirstlane_b32 s50, v125
    s_cmp_lt_u32 s50, 8
    s_cbranch_scc0 L_m_45
L_m_45_r:
    s_sleep 1
    ds_read_b32 v125, v126 offset:24
    s_waitcnt lgkmcnt(0)
    v_readfirstlane_b32 s50, v125
    s_cmp_lt_u32 s50, 8
    s_cbranch_scc1 L_m_45_r
L_m_45:
    ds_read_b64_tr_b16 v[128:129], v112 offset:0
    ds_read_b64_tr_b16 v[130:131], v112 offset:1024
    ds_read_b64_tr_b16 v[132:133], v115 offset:0
    ds_read_b64_tr_b16 v[134:135], v115 offset:1024
    ds_read_b64_tr_b16 v[136:137], v113 offset:0
    ds_read_b64_tr_b16 v[138:139], v113 offset:1024
    ds_read_b64_tr_b16 v[140:141], v118 offset:0
    ds_read_b64_tr_b16 v[142:143], v118 offset:1024
    ds_read_b64_tr_b16 v[144:145], v112 offset:4096
    ds_read_b64_tr_b16 v[146:147], v112 offset:5120
    ds_read_b64_tr_b16 v[148:149], v115 offset:4096
    ds_read_b64_tr_b16 v[150:151], v115 offset:5120
    ds_read_b64_tr_b16 v[152:153], v113 offset:4096
    ds_read_b64_tr_b16 v[154:155], v113 offset:5120
    ds_read_b64_tr_b16 v[156:157], v118 offset:4096
    ds_read_b64_tr_b16 v[158:159], v118 offset:5120
    ds_read_b64_tr_b16 v[160:161], v112 offset:8192
    ds_read_b64_tr_b16 v[162:163], v112 offset:9216
    ds_read_b64_tr_b16 v[164:165], v115 offset:8192
    ds_read_b64_tr_b16 v[166:167], v115 offset:9216
    ds_read_b64_tr_b16 v[168:169], v113 offset:8192
    ds_read_b64_tr_b16 v[170:171], v113 offset:9216
    ds_read_b64_tr_b16 v[172:173], v118 offset:8192
    ds_read_b64_tr_b16 v[174:175], v118 offset:9216
    ds_read_b64_tr_b16 v[176:177], v112 offset:12288
    ds_read_b64_tr_b16 v[178:179], v112 offset:13312
    ds_read_b64_tr_b16 v[180:181], v115 offset:12288
    ds_read_b64_tr_b16 v[182:183], v115 offset:13312
    ds_read_b64_tr_b16 v[184:185], v113 offset:12288
    ds_read_b64_tr_b16 v[186:187], v113 offset:13312
    buffer_load_dword v12, v114, s[16:19], s68 offen sc1
    ds_read_b64_tr_b16 v[188:189], v118 offset:12288
    ds_read_b64_tr_b16 v[190:191], v118 offset:13312
    ds_read_b64_tr_b16 v[192:193], v112 offset:16384
    ds_read_b64_tr_b16 v[194:195], v112 offset:17408
    ds_read_b64_tr_b16 v[196:197], v115 offset:16384
    ds_read_b64_tr_b16 v[198:199], v115 offset:17408
    ds_read_b64_tr_b16 v[200:201], v113 offset:16384
    ds_read_b64_tr_b16 v[202:203], v113 offset:17408
    ds_read_b64_tr_b16 v[204:205], v118 offset:16384
    ds_read_b64_tr_b16 v[206:207], v118 offset:17408
    ds_read_b64_tr_b16 v[208:209], v112 offset:20480
    ds_read_b64_tr_b16 v[210:211], v112 offset:21504
    ds_read_b64_tr_b16 v[212:213], v115 offset:20480
    ds_read_b64_tr_b16 v[214:215], v115 offset:21504
    ds_read_b64_tr_b16 v[216:217], v113 offset:20480
    ds_read_b64_tr_b16 v[218:219], v113 offset:21504
    ds_read_b64_tr_b16 v[220:221], v118 offset:20480
    ds_read_b64_tr_b16 v[222:223], v118 offset:21504
    ds_read_b64_tr_b16 v[224:225], v112 offset:24576
    ds_read_b64_tr_b16 v[226:227], v112 offset:25600
    ds_read_b64_tr_b16 v[228:229], v115 offset:24576
    ds_read_b64_tr_b16 v[230:231], v115 offset:25600
    ds_read_b64_tr_b16 v[232:233], v113 offset:24576
    ds_read_b64_tr_b16 v[234:235], v113 offset:25600
    ds_read_b64_tr_b16 v[236:237], v118 offset:24576
    ds_read_b64_tr_b16 v[238:239], v118 offset:25600
    ds_read_b64_tr_b16 v[240:241], v112 offset:28672
    ds_read_b64_tr_b16 v[242:243], v112 offset:29696
    ds_read_b64_tr_b16 v[244:245], v115 offset:28672
    ds_read_b64_tr_b16 v[246:247], v115 offset:29696
    ds_read_b64_tr_b16 v[248:249], v113 offset:28672
    ds_read_b64_tr_b16 v[250:251], v113 offset:29696
    ds_read_b64_tr_b16 v[252:253], v118 offset:28672
    ds_read_b64_tr_b16 v[254:255], v118 offset:29696
    s_waitcnt vmcnt(0)
    v_cmp_ne_u32 vcc, s47, v12
    s_mov_b32 s51, 1
    s_cbranch_vccz L_o_46
L_o_46_r:
    s_add_u32 s51, s51, 1
    s_cmp_gt_u32 s51, 0x10000
    s_cbranch_scc1 L_o_46
    s_sleep 2
    buffer_load_dword v12, v114, s[16:19], s68 offen sc1
    s_waitcnt vmcnt(0)
    v_cmp_ne_u32 vcc, s47, v12
    s_nop 0
    s_cbranch_vccnz L_o_46_r
L_o_46:
L_G:
L_TP0_2:
    s_cbranch_execz L_TretP
    s_nop 0
    buffer_load_dwordx4 v[48:51], v119, s[16:19], s72 offen offset:0 sc1
    buffer_load_dwordx4 v[52:55], v119, s[16:19], s72 offen offset:256 sc1
    buffer_load_dwordx4 v[56:59], v119, s[16:19], s72 offen offset:2048 sc1
    buffer_load_dwordx4 v[60:63], v119, s[16:19], s72 offen offset:2304 sc1
    buffer_load_dwordx4 v[64:67], v119, s[16:19], s73 offen offset:0 sc1
    buffer_load_dwordx4 v[68:71], v119, s[16:19], s73 offen offset:256 sc1
L_G2:
    ds_read_b32 v125, v126 offset:24
    v_and_b32 v1, 15, v0
    v_lshrrev_b32 v2, 4, v0
    v_and_b32 v3, 7, v0
    v_xor_b32 v2, v2, v3
    v_lshlrev_b32 v2, 4, v2
    v_lshl_add_u32 v1, v1, 8, v2
    s_lshl_b32 s50, s40, 13
    s_add_u32 s50, s50, 0x10000
    v_add_u32 v1, s50, v1
    v_lshrrev_b32 v9, 3, v0
    v_lshlrev_b32 v7, 1, v3
    v_xor_b32 v7, v7, v9
    v_lshlrev_b32 v7, 4, v7
    v_lshl_add_u32 v7, v9, 8, v7
    s_lshl_b32 s50, s40, 11
    s_add_u32 s50, s50, 0x10000
    v_add_u32 v7, s50, v7
    v_xor_b32 v8, 16, v7
    v_lshlrev_b32 v10, 11, v9
    v_lshl_add_u32 v10, v3, 4, v10
    s_lshl_b32 s50, s40, 5
    s_add_u32 s50, s50, 0x26800
    v_lshlrev_b32 v9, 2, v9
    v_add_u32 v9, s50, v9
    v_xor_b32 v2, 32, v1
    v_xor_b32 v3, 64, v1
    v_xor_b32 v4, 0x60, v1
    s_waitcnt lgkmcnt(0)
    s_mov_b32 s51, 0
    s_waitcnt vmcnt(5)
    v_max3_u32 v12, v48, v49, v50
    v_max_u32 v12, v12, v51
    v_cmp_eq_u32 vcc, -1, v12
    s_nop 0
    s_cbranch_vccnz L_fv_47_r
L_fv_47:
    s_cmp_eq_u32 s85, 0
    s_cbranch_scc1 L_bp_48
    s_setprio 1
L_bp_48:
    v_mfma_f32_16x16x32_bf16 v[16:19], v[128:131], v[48:51], 0
    v_mfma_f32_16x16x32_bf16 v[20:23], v[132:135], v[48:51], 0
    buffer_load_dwordx4 v[72:75], v119, s[16:19], s73 offen offset:2048 sc1
    s_waitcnt vmcnt(5)
    v_max3_u32 v12, v52, v53, v54
    v_max_u32 v12, v12, v55
    v_cmp_eq_u32_e64 vcc, -1, v12
    v_mfma_f32_16x16x32_bf16 v[32:35], v[136:139], v[48:51], 0
    v_mfma_f32_16x16x32_bf16 v[36:39], v[140:143], v[48:51], 0
    s_cbranch_vccnz L_fv_49_r
L_fv_49:
    v_mfma_f32_16x16x32_bf16 v[24:27], v[128:131], v[52:55], 0
    v_mfma_f32_16x16x32_bf16 v[28:31], v[132:135], v[52:55], 0
    buffer_load_dwordx4 v[76:79], v119, s[16:19], s73 offen offset:2304 sc1
    s_waitcnt vmcnt(5)
    v_max3_u32 v12, v56, v57, v58
    v_max_u32 v12, v12, v59
    v_cmp_eq_u32 vcc, -1, v12
    v_mfma_f32_16x16x32_bf16 v[40:43], v[136:139], v[52:55], 0
    v_mfma_f32_16x16x32_bf16 v[44:47], v[140:143], v[52:55], 0
    s_cbranch_vccnz L_fv_50_r
L_fv_50:
    v_mfma_f32_16x16x32_bf16 v[16:19], v[144:147], v[56:59], v[16:19]
    v_mfma_f32_16x16x32_bf16 v[20:23], v[148:151], v[56:59], v[20:23]
    buffer_load_dwordx4 v[80:83], v119, s[16:19], s74 offen offset:0 sc1
    s_waitcnt vmcnt(5)
    v_max3_u32 v12, v60, v61, v62
    v_max_u32 v12, v12, v63
    v_cmp_eq_u32 vcc, -1, v12
    v_mfma_f32_16x16x32_bf16 v[32:35], v[152:155], v[56:59], v[32:35]
    v_mfma_f32_16x16x32_bf16 v[36:39], v[156:159], v[56:59], v[36:39]
    s_cbranch_vccnz L_fv_51_r
L_fv_51:
    v_mfma_f32_16x16x32_bf16 v[24:27], v[144:147], v[60:63], v[24:27]
    v_mfma_f32_16x16x32_bf16 v[28:31], v[148:151], v[60:63], v[28:31]
    buffer_load_dwordx4 v[84:87], v119, s[16:19], s74 offen offset:256 sc1
    s_waitcnt vmcnt(5)
    v_max3_u32 v12, v64, v65, v66
    v_max_u32 v12, v12, v67
    v_cmp_eq_u32 vcc, -1, v12
    v_mfma_f32_16x16x32_bf16 v[40:43], v[152:155], v[60:63], v[40:43]
    v_mfma_f32_16x16x32_bf16 v[44:47], v[156:159], v[60:63], v[44:47]
    s_cbranch_vccnz L_fv_52_r
L_fv_52:
    v_mfma_f32_16x16x32_bf16 v[16:19], v[160:163], v[64:67], v[16:19]
    v_mfma_f32_16x16x32_bf16 v[20:23], v[164:167], v[64:67], v[20:23]
    buffer_load_dwordx4 v[88:91], v119, s[16:19], s74 offen offset:2048 sc1
    s_waitcnt vmcnt(5)
    v_max3_u32 v12, v68, v69, v70
    v_max_u32 v12, v12, v71
    v_cmp_eq_u32 vcc, -1, v12
    v_mfma_f32_16x16x32_bf16 v[32:35], v[168:171], v[64:67], v[32:35]
    v_mfma_f32_16x16x32_bf16 v[36:39], v[172:175], v[64:67], v[36:39]
    s_cbranch_vccnz L_fv_53_r
L_fv_53:
    v_mfma_f32_16x16x32_bf16 v[24:27], v[160:163], v[68:71], v[24:27]
    v_mfma_f32_16x16x32_bf16 v[28:31], v[164:167], v[68:71], v[28:31]
    buffer_load_dwordx4 v[92:95], v119, s[16:19], s74 offen offset:2304 sc1
    s_waitcnt vmcnt(5)
    v_max3_u32 v12, v72, v73, v74
    v_max_u32 v12, v12, v75
    v_cmp_eq_u32 vcc, -1, v12
    v_mfma_f32_16x16x32_bf16 v[40:43], v[168:171], v[68:71], v[40:43]
    v_mfma_f32_16x16x32_bf16 v[44:47], v[172:175], v[68:71], v[44:47]
    s_cbranch_vccnz L_fv_54_r
L_fv_54:
    v_mfma_f32_16x16x32_bf16 v[16:19], v[176:179], v[72:75], v[16:19]
    v_mfma_f32_16x16x32_bf16 v[20:23], v[180:183], v[72:75], v[20:23]
    buffer_load_dwordx4 v[96:99], v119, s[16:19], s75 offen offset:0 sc1
    s_waitcnt vmcnt(5)
    v_max3_u32 v12, v76, v77, v78
    v_max_u32 v12, v12, v79
    v_cmp_eq_u32 vcc, -1, v12
    v_mfma_f32_16x16x32_bf16 v[32:35], v[184:187], v[72:75], v[32:35]
    v_mfma_f32_16x16x32_bf16 v[36:39], v[188:191], v[72:75], v[36:39]
    s_cbranch_vccnz L_fv_55_r
L_fv_55:
    v_mfma_f32_16x16x32_bf16 v[24:27], v[176:179], v[76:79], v[24:27]
    v_mfma_f32_16x16x32_bf16 v[28:31], v[180:183], v[76:79], v[28:31]
    buffer_load_dwordx4 v[100:103], v119, s[16:19], s75 offen offset:256 sc1
    s_waitcnt vmcnt(5)
    v_max3_u32 v12, v80, v81, v82
    v_max_u32 v12, v12, v83
    v_cmp_eq_u32 vcc, -1, v12
    v_mfma_f32_16x16x32_bf16 v[40:43], v[184:187], v[76:79], v[40:43]
    v_mfma_f32_16x16x32_bf16 v[44:47], v[188:191], v[76:79], v[44:47]
    s_cbranch_vccnz L_fv_56_r
L_fv_56:
    v_mfma_f32_16x16x32_bf16 v[16:19], v[192:195], v[80:83], v[16:19]
    v_mfma_f32_16x16x32_bf16 v[20:23], v[196:199], v[80:83], v[20:23]
    buffer_load_dwordx4 v[104:107], v119, s[16:19], s75 offen offset:2048 sc1
    s_waitcnt vmcnt(5)
    v_max3_u32 v12, v84, v85, v86
    v_max_u32 v12, v12, v87
    v_cmp_eq_u32 vcc, -1, v12
    v_mfma_f32_16x16x32_bf16 v[32:35], v[200:203], v[80:83], v[32:35]
    v_mfma_f32_16x16x32_bf16 v[36:39], v[204:207], v[80:83], v[36:39]
    s_cbranch_vccnz L_fv_57_r
L_fv_57:
    v_mfma_f32_16x16x32_bf16 v[24:27], v[192:195], v[84:87], v[24:27]
    v_mfma_f32_16x16x32_bf16 v[28:31], v[196:199], v[84:87], v[28:31]
    buffer_load_dwordx4 v[108:111], v119, s[16:19], s75 offen offset:2304 sc1
    s_waitcnt vmcnt(5)
    v_max3_u32 v12, v88, v89, v90
    v_max_u32 v12, v12, v91
    v_cmp_eq_u32 vcc, -1, v12
    v_mfma_f32_16x16x32_bf16 v[40:43], v[200:203], v[84:87], v[40:43]
    v_mfma_f32_16x16x32_bf16 v[44:47], v[204:207], v[84:87], v[44:47]
    s_cbranch_vccnz L_fv_58_r
L_fv_58:
    v_mfma_f32_16x16x32_bf16 v[16:19], v[208:211], v[88:91], v[16:19]
    v_mfma_f32_16x16x32_bf16 v[20:23], v[212:215], v[88:91], v[20:23]
    s_waitcnt vmcnt(4)
    v_max3_u32 v12, v92, v93, v94
    v_max_u32 v12, v12, v95
    v_cmp_eq_u32 vcc, -1, v12
    v_mfma_f32_16x16x32_bf16 v[32:35], v[216:219], v[88:91], v[32:35]
    v_mfma_f32_16x16x32_bf16 v[36:39], v[220:223], v[88:91], v[36:39]
    s_cbranch_vccnz L_fv_59_r
L_fv_59:
    v_mfma_f32_16x16x32_bf16 v[24:27], v[208:211], v[92:95], v[24:27]
    v_mfma_f32_16x16x32_bf16 v[28:31], v[212:215], v[92:95], v[28:31]
    s_waitcnt vmcnt(3)
    v_max3_u32 v12, v96, v97, v98
    v_max_u32 v12, v12, v99
    v_cmp_eq_u32 vcc, -1, v12
    v_mfma_f32_16x16x32_bf16 v[40:43], v[216:219], v[92:95], v[40:43]
    v_mfma_f32_16x16x32_bf16 v[44:47], v[220:223], v[92:95], v[44:47]
    s_cbranch_vccnz L_fv_60_r
L_fv_60:
    v_mfma_f32_16x16x32_bf16 v[16:19], v[224:227], v[96:99], v[16:19]
    v_mfma_f32_16x16x32_bf16 v[20:23], v[228:231], v[96:99], v[20:23]
    v_readfirstlane_b32 s50, v125
    s_cmp_lt_u32 s50, 8
    s_cbranch_scc0 L_o_61
L_o_61_r:
    s_sleep 1
    ds_read_b32 v125, v126 offset:24
    s_waitcnt lgkmcnt(0)
    v_readfirstlane_b32 s50, v125
    s_cmp_lt_u32 s50, 8
    s_cbranch_scc1 L_o_61_r
L_o_61:
    s_lshl_b32 s50, s79, 7
    s_add_u32 s50, s50, 0x26800
    v_add_u32 v5, s50, v5
    s_cmp_eq_u32 s85, 0
    s_cselect_b32 s50, 0x26900, 0
    v_max_u32_e64 v5, s50, v5
    v_min_u32 v5, 0x26900, v5
    ds_write_b32 v5, v6
    s_waitcnt vmcnt(2)
    v_max3_u32 v12, v100, v101, v102
    v_max_u32 v12, v12, v103
    v_cmp_eq_u32_e64 vcc, -1, v12
    v_mfma_f32_16x16x32_bf16 v[32:35], v[232:235], v[96:99], v[32:35]
    v_mfma_f32_16x16x32_bf16 v[36:39], v[236:239], v[96:99], v[36:39]
    s_cbranch_vccnz L_fv_62_r
L_fv_62:
    v_mfma_f32_16x16x32_bf16 v[24:27], v[224:227], v[100:103], v[24:27]
    v_mfma_f32_16x16x32_bf16 v[28:31], v[228:231], v[100:103], v[28:31]
    s_waitcnt vmcnt(1)
    v_max3_u32 v12, v104, v105, v106
    v_max_u32 v12, v12, v107
    v_cmp_eq_u32 vcc, -1, v12
    v_mfma_f32_16x16x32_bf16 v[40:43], v[232:235], v[100:103], v[40:43]
    v_mfma_f32_16x16x32_bf16 v[44:47], v[236:239], v[100:103], v[44:47]
    s_cbranch_vccnz L_fv_63_r
L_fv_63:
    v_mfma_f32_16x16x32_bf16 v[16:19], v[240:243], v[104:107], v[16:19]
    v_mfma_f32_16x16x32_bf16 v[20:23], v[244:247], v[104:107], v[20:23]
    s_waitcnt vmcnt(0)
    v_max3_u32 v12, v108, v109, v110
    v_max_u32 v12, v12, v111
    v_cmp_eq_u32 vcc, -1, v12
    v_mfma_f32_16x16x32_bf16 v[32:35], v[248:251], v[104:107], v[32:35]
    v_mfma_f32_16x16x32_bf16 v[36:39], v[252:255], v[104:107], v[36:39]
    s_cbranch_vccnz L_fv_64_r
L_fv_64:
    v_mfma_f32_16x16x32_bf16 v[24:27], v[240:243], v[108:111], v[24:27]
    v_mfma_f32_16x16x32_bf16 v[28:31], v[244:247], v[108:111], v[28:31]
    v_mfma_f32_16x16x32_bf16 v[40:43], v[248:251], v[108:111], v[40:43]
    v_mfma_f32_16x16x32_bf16 v[44:47], v[252:255], v[108:111], v[44:47]
L_Gf:
    ds_write_b128 v1, v[16:19] offset:0
    ds_write_b128 v3, v[20:23] offset:0
    s_nop 2
    ds_write_b128 v1, v[24:27] offset:4096
    ds_write_b128 v3, v[28:31] offset:4096
    ds_write_b128 v1, v[32:35] offset:128
    ds_write_b128 v3, v[36:39] offset:128
    ds_write_b128 v1, v[40:43] offset:4224
    ds_write_b128 v3, v[44:47] offset:4224
    s_waitcnt lgkmcnt(0)
    s_barrier
    ds_read_b32 v12, v9
    ds_read_b128 v[16:19], v7 offset:0
    ds_read_b128 v[20:23], v8 offset:0
    ds_read_b128 v[24:27], v7 offset:16384
    ds_read_b128 v[28:31], v8 offset:16384
    ds_read_b128 v[32:35], v7 offset:32768
    ds_read_b128 v[36:39], v8 offset:32768
    ds_read_b128 v[40:43], v7 offset:49152
    ds_read_b128 v[44:47], v8 offset:49152
    s_waitcnt lgkmcnt(6)
    v_sub_f32 v14, 1.0, v12
    v_pk_mul_f32 v[16:17], v[16:17], v[12:13] op_sel_hi:[1,0]
    v_pk_mul_f32 v[18:19], v[18:19], v[12:13] op_sel_hi:[1,0]
    v_pk_mul_f32 v[20:21], v[20:21], v[12:13] op_sel_hi:[1,0]
    v_pk_mul_f32 v[22:23], v[22:23], v[12:13] op_sel_hi:[1,0]
    s_waitcnt lgkmcnt(4)
    v_pk_fma_f32 v[16:17], v[24:25], v[12:13], v[16:17] op_sel_hi:[1,0,1]
    v_pk_fma_f32 v[18:19], v[26:27], v[12:13], v[18:19] op_sel_hi:[1,0,1]
    v_pk_fma_f32 v[20:21], v[28:29], v[12:13], v[20:21] op_sel_hi:[1,0,1]
    v_pk_fma_f32 v[22:23], v[30:31], v[12:13], v[22:23] op_sel_hi:[1,0,1]
    s_waitcnt lgkmcnt(2)
    v_pk_fma_f32 v[16:17], v[32:33], v[14:15], v[16:17] op_sel_hi:[1,0,1]
    v_pk_fma_f32 v[18:19], v[34:35], v[14:15], v[18:19] op_sel_hi:[1,0,1]
    v_pk_fma_f32 v[20:21], v[36:37], v[14:15], v[20:21] op_sel_hi:[1,0,1]
    v_pk_fma_f32 v[22:23], v[38:39], v[14:15], v[22:23] op_sel_hi:[1,0,1]
    s_waitcnt lgkmcnt(0)
    v_pk_fma_f32 v[16:17], v[40:41], v[14:15], v[16:17] op_sel_hi:[1,0,1]
    v_pk_fma_f32 v[18:19], v[42:43], v[14:15], v[18:19] op_sel_hi:[1,0,1]
    v_pk_fma_f32 v[20:21], v[44:45], v[14:15], v[20:21] op_sel_hi:[1,0,1]
    v_pk_fma_f32 v[22:23], v[46:47], v[14:15], v[22:23] op_sel_hi:[1,0,1]
    v_cvt_pk_bf16_f32 v16, v16, v17
    v_cvt_pk_bf16_f32 v17, v18, v19
    v_cvt_pk_bf16_f32 v18, v20, v21
    v_cvt_pk_bf16_f32 v19, v22, v23
    buffer_store_dwordx4 v[16:19], v10, s[28:31], s76 offen sc1
L_fin:
L_end:
    s_endpgm
L_fv_47_r:
    s_add_u32 s51, s51, 1
    s_cmp_gt_u32 s51, 0x10000
    s_cbranch_scc1 L_fv_47
    buffer_load_dwordx4 v[48:51], v119, s[16:19], s72 offen offset:0 sc1
    buffer_load_dwordx4 v[52:55], v119, s[16:19], s72 offen offset:256 sc1
    buffer_load_dwordx4 v[56:59], v119, s[16:19], s72 offen offset:2048 sc1
    buffer_load_dwordx4 v[60:63], v119, s[16:19], s72 offen offset:2304 sc1
    s_waitcnt vmcnt(0)
    v_max3_u32 v12, v48, v49, v50
    v_max_u32 v12, v12, v51
    v_cmp_eq_u32 vcc, -1, v12
    s_nop 0
    s_cbranch_vccnz L_fv_47_r
    s_branch L_fv_47
L_fv_49_r:
    s_add_u32 s51, s51, 1
    s_cmp_gt_u32 s51, 0x10000
    s_cbranch_scc1 L_fv_49
    buffer_load_dwordx4 v[52:55], v119, s[16:19], s72 offen offset:256 sc1
    buffer_load_dwordx4 v[56:59], v119, s[16:19], s72 offen offset:2048 sc1
    buffer_load_dwordx4 v[60:63], v119, s[16:19], s72 offen offset:2304 sc1
    s_waitcnt vmcnt(0)
    v_max3_u32 v12, v52, v53, v54
    v_max_u32 v12, v12, v55
    v_cmp_eq_u32 vcc, -1, v12
    s_nop 0
    s_cbranch_vccnz L_fv_49_r
    s_branch L_fv_49
L_fv_50_r:
    s_add_u32 s51, s51, 1
    s_cmp_gt_u32 s51, 0x10000
    s_cbranch_scc1 L_fv_50
    buffer_load_dwordx4 v[56:59], v119, s[16:19], s72 offen offset:2048 sc1
    buffer_load_dwordx4 v[60:63], v119, s[16:19], s72 offen offset:2304 sc1
    s_waitcnt vmcnt(0)
    v_max3_u32 v12, v56, v57, v58
    v_max_u32 v12, v12, v59
    v_cmp_eq_u32 vcc, -1, v12
    s_nop 0
    s_cbranch_vccnz L_fv_50_r
    s_branch L_fv_50
L_fv_51_r:
    s_add_u32 s51, s51, 1
    s_cmp_gt_u32 s51, 0x10000
    s_cbranch_scc1 L_fv_51
    buffer_load_dwordx4 v[60:63], v119, s[16:19], s72 offen offset:2304 sc1
    s_waitcnt vmcnt(0)
    v_max3_u32 v12, v60, v61, v62
    v_max_u32 v12, v12, v63
    v_cmp_eq_u32 vcc, -1, v12
    s_nop 0
    s_cbranch_vccnz L_fv_51_r
    s_branch L_fv_51
L_fv_52_r:
    s_add_u32 s51, s51, 1
    s_cmp_gt_u32 s51, 0x10000
    s_cbranch_scc1 L_fv_52
    buffer_load_dwordx4 v[64:67], v119, s[16:19], s73 offen offset:0 sc1
    buffer_load_dwordx4 v[68:71], v119, s[16:19], s73 offen offset:256 sc1
    buffer_load_dwordx4 v[72:75], v119, s[16:19], s73 offen offset:2048 sc1
    buffer_load_dwordx4 v[76:79], v119, s[16:19], s73 offen offset:2304 sc1
    s_waitcnt vmcnt(0)
    v_max3_u32 v12, v64, v65, v66
    v_max_u32 v12, v12, v67
    v_cmp_eq_u32 vcc, -1, v12
    s_nop 0
    s_cbranch_vccnz L_fv_52_r
    s_branch L_fv_52
L_fv_53_r:
    s_add_u32 s51, s51, 1
    s_cmp_gt_u32 s51, 0x10000
    s_cbranch_scc1 L_fv_53
    buffer_load_dwordx4 v[68:71], v119, s[16:19], s73 offen offset:256 sc1
    buffer_load_dwordx4 v[72:75], v119, s[16:19], s73 offen offset:2048 sc1
    buffer_load_dwordx4 v[76:79], v119, s[16:19], s73 offen offset:2304 sc1
    s_waitcnt vmcnt(0)
    v_max3_u32 v12, v68, v69, v70
    v_max_u32 v12, v12, v71
    v_cmp_eq_u32 vcc, -1, v12
    s_nop 0
    s_cbranch_vccnz L_fv_53_r
    s_branch L_fv_53
L_fv_54_r:
    s_add_u32 s51, s51, 1
    s_cmp_gt_u32 s51, 0x10000
    s_cbranch_scc1 L_fv_54
    buffer_load_dwordx4 v[72:75], v119, s[16:19], s73 offen offset:2048 sc1
    buffer_load_dwordx4 v[76:79], v119, s[16:19], s73 offen offset:2304 sc1
    s_waitcnt vmcnt(0)
    v_max3_u32 v12, v72, v73, v74
    v_max_u32 v12, v12, v75
    v_cmp_eq_u32 vcc, -1, v12
    s_nop 0
    s_cbranch_vccnz L_fv_54_r
    s_branch L_fv_54
L_fv_55_r:
    s_add_u32 s51, s51, 1
    s_cmp_gt_u32 s51, 0x10000
    s_cbranch_scc1 L_fv_55
    buffer_load_dwordx4 v[76:79], v119, s[16:19], s73 offen offset:2304 sc1
    s_waitcnt vmcnt(0)
    v_max3_u32 v12, v76, v77, v78
    v_max_u32 v12, v12, v79
    v_cmp_eq_u32 vcc, -1, v12
    s_nop 0
    s_cbranch_vccnz L_fv_55_r
    s_branch L_fv_55
L_fv_56_r:
    s_add_u32 s51, s51, 1
    s_cmp_gt_u32 s51, 0x10000
    s_cbranch_scc1 L_fv_56
    buffer_load_dwordx4 v[80:83], v119, s[16:19], s74 offen offset:0 sc1
    buffer_load_dwordx4 v[84:87], v119, s[16:19], s74 offen offset:256 sc1
    buffer_load_dwordx4 v[88:91], v119, s[16:19], s74 offen offset:2048 sc1
    buffer_load_dwordx4 v[92:95], v119, s[16:19], s74 offen offset:2304 sc1
    s_waitcnt vmcnt(0)
    v_max3_u32 v12, v80, v81, v82
    v_max_u32 v12, v12, v83
    v_cmp_eq_u32 vcc, -1, v12
    s_nop 0
    s_cbranch_vccnz L_fv_56_r
    s_branch L_fv_56
L_fv_57_r:
    s_add_u32 s51, s51, 1
    s_cmp_gt_u32 s51, 0x10000
    s_cbranch_scc1 L_fv_57
    buffer_load_dwordx4 v[84:87], v119, s[16:19], s74 offen offset:256 sc1
    buffer_load_dwordx4 v[88:91], v119, s[16:19], s74 offen offset:2048 sc1
    buffer_load_dwordx4 v[92:95], v119, s[16:19], s74 offen offset:2304 sc1
    s_waitcnt vmcnt(0)
    v_max3_u32 v12, v84, v85, v86
    v_max_u32 v12, v12, v87
    v_cmp_eq_u32 vcc, -1, v12
    s_nop 0
    s_cbranch_vccnz L_fv_57_r
    s_branch L_fv_57
L_fv_58_r:
    s_add_u32 s51, s51, 1
    s_cmp_gt_u32 s51, 0x10000
    s_cbranch_scc1 L_fv_58
    buffer_load_dwordx4 v[88:91], v119, s[16:19], s74 offen offset:2048 sc1
    buffer_load_dwordx4 v[92:95], v119, s[16:19], s74 offen offset:2304 sc1
    s_waitcnt vmcnt(0)
    v_max3_u32 v12, v88, v89, v90
    v_max_u32 v12, v12, v91
    v_cmp_eq_u32 vcc, -1, v12
    s_nop 0
    s_cbranch_vccnz L_fv_58_r
    s_branch L_fv_58
L_fv_59_r:
    s_add_u32 s51, s51, 1
    s_cmp_gt_u32 s51, 0x10000
    s_cbranch_scc1 L_fv_59
    buffer_load_dwordx4 v[92:95], v119, s[16:19], s74 offen offset:2304 sc1
    s_waitcnt vmcnt(0)
    v_max3_u32 v12, v92, v93, v94
    v_max_u32 v12, v12, v95
    v_cmp_eq_u32 vcc, -1, v12
    s_nop 0
    s_cbranch_vccnz L_fv_59_r
    s_branch L_fv_59
L_fv_60_r:
    s_add_u32 s51, s51, 1
    s_cmp_gt_u32 s51, 0x10000
    s_cbranch_scc1 L_fv_60
    buffer_load_dwordx4 v[96:99], v119, s[16:19], s75 offen offset:0 sc1
    buffer_load_dwordx4 v[100:103], v119, s[16:19], s75 offen offset:256 sc1
    buffer_load_dwordx4 v[104:107], v119, s[16:19], s75 offen offset:2048 sc1
    buffer_load_dwordx4 v[108:111], v119, s[16:19], s75 offen offset:2304 sc1
    s_waitcnt vmcnt(0)
    v_max3_u32 v12, v96, v97, v98
    v_max_u32 v12, v12, v99
    v_cmp_eq_u32 vcc, -1, v12
    s_nop 0
    s_cbranch_vccnz L_fv_60_r
    s_branch L_fv_60
L_fv_62_r:
    s_add_u32 s51, s51, 1
    s_cmp_gt_u32 s51, 0x10000
    s_cbranch_scc1 L_fv_62
    buffer_load_dwordx4 v[100:103], v119, s[16:19], s75 offen offset:256 sc1
    buffer_load_dwordx4 v[104:107], v119, s[16:19], s75 offen offset:2048 sc1
    buffer_load_dwordx4 v[108:111], v119, s[16:19], s75 offen offset:2304 sc1
    s_waitcnt vmcnt(0)
    v_max3_u32 v12, v100, v101, v102
    v_max_u32 v12, v12, v103
    v_cmp_eq_u32 vcc, -1, v12
    s_nop 0
    s_cbranch_vccnz L_fv_62_r
    s_branch L_fv_62
L_fv_63_r:
    s_add_u32 s51, s51, 1
    s_cmp_gt_u32 s51, 0x10000
    s_cbranch_scc1 L_fv_63
    buffer_load_dwordx4 v[104:107], v119, s[16:19], s75 offen offset:2048 sc1
    buffer_load_dwordx4 v[108:111], v119, s[16:19], s75 offen offset:2304 sc1
    s_waitcnt vmcnt(0)
    v_max3_u32 v12, v104, v105, v106
    v_max_u32 v12, v12, v107
    v_cmp_eq_u32 vcc, -1, v12
    s_nop 0
    s_cbranch_vccnz L_fv_63_r
    s_branch L_fv_63
L_fv_64_r:
    s_add_u32 s51, s51, 1
    s_cmp_gt_u32 s51, 0x10000
    s_cbranch_scc1 L_fv_64
    buffer_load_dwordx4 v[108:111], v119, s[16:19], s75 offen offset:2304 sc1
    s_waitcnt vmcnt(0)
    v_max3_u32 v12, v108, v109, v110
    v_max_u32 v12, v12, v111
    v_cmp_eq_u32 vcc, -1, v12
    s_nop 0
    s_cbranch_vccnz L_fv_64_r
    s_branch L_fv_64
L_last:
.section .rodata,"a"
.p2align 6
.amdhsa_kernel gated_mix__linear_kernel_hedgehog__sliding_local_dilated__prompt_kernel
  .amdhsa_next_free_vgpr 256
  .amdhsa_next_free_sgpr 102
  .amdhsa_accum_offset 256
  .amdhsa_group_segment_fixed_size 0
  .amdhsa_kernarg_size 88
  .amdhsa_user_sgpr_count 2
  .amdhsa_user_sgpr_kernarg_segment_ptr 1
  .amdhsa_system_sgpr_workgroup_id_x 1
.end_amdhsa_kernel
```
